```python
import torch

def _softmax(x, axis=-1):
    return torch.softmax(x, dim=axis)
def _gelu(x):
    return torch.nn.functional.gelu(x, approximate="tanh")
def _silu(x):
    return torch.nn.functional.silu(x)
def _sigmoid(x):
    return torch.sigmoid(x)
def _layernorm(x, axis=-1, eps=1e-5):
    m = x.mean(dim=axis, keepdim=True)
    v = x.var(dim=axis, keepdim=True, unbiased=False)
    return (x - m) / torch.sqrt(v + eps)
def _scatter_add(tgt, idx, src, axis=0):
    return tgt.clone().index_add_(axis, idx, src)
def _segment_sum(src, seg, n):
    out = torch.zeros((n,) + src.shape[1:], dtype=src.dtype)
    return out.index_add_(0, seg, src)
def _pad(x, pw):
    flat = tuple(v for pair in reversed(pw) for v in pair)
    return torch.nn.functional.pad(x, flat)

kernel_name = 'sequential_preLN__linear_kernel_hedgehog__mixer_token_mlp__prompt'

def setup_inputs():

    _w = (lambda a: (lambda t: t.to(torch.bfloat16) if t.is_floating_point() else t)(torch.as_tensor(a)))
    def _A_setup():
        B, S, D, H = 1, 2048, 448, 16
        Dh = D // H
        return {
            "x": _w((lambda *s: torch.randn(*s, dtype=torch.bfloat16) * 0.05)(B, S, D)),
            "wqkv": _w((lambda *s: torch.randn(*s, dtype=torch.bfloat16) * 0.2)(D, 3 * D)),
            "w_phi": _w((lambda *s: torch.randn(*s, dtype=torch.bfloat16) * 0.2)(H, Dh, Dh) * (Dh ** -0.5)),
            "wo": _w((lambda *s: torch.randn(*s, dtype=torch.bfloat16) * 0.05)(D, D)),
        }
    _A_in = _A_setup()

    def _B_setup():
        B, S, D, F = 1, 2048, 448, 1792
        return {
            "x": _w((lambda *s: torch.randn(*s, dtype=torch.bfloat16) * 0.05)(B, S, D)),
            "w1": _w((lambda *s: torch.randn(*s, dtype=torch.bfloat16) * 0.2)(S, F) * (S ** -0.5)),
            "b1": _w((lambda *s: torch.randn(*s, dtype=torch.bfloat16) * 3.2)(F) * 0.02),
            "w2": _w((lambda *s: torch.randn(*s, dtype=torch.bfloat16) * 0.8)(F, S) * (F ** -0.5)),
            "b2": _w((lambda *s: torch.randn(*s, dtype=torch.bfloat16) * 3.2)(S) * 0.02),
        }
    _B_in = _B_setup()

    return {
        "A_x": _A_in["x"],
        "A_wqkv": _A_in["wqkv"],
        "A_w_phi": _A_in["w_phi"],
        "A_wo": _A_in["wo"],
        "B_x": _B_in["x"],
        "B_w1": _B_in["w1"],
        "B_b1": _B_in["b1"],
        "B_w2": _B_in["w2"],
        "B_b2": _B_in["b2"],
    }

def reference(A_x, A_wqkv, A_w_phi, A_wo, B_x, B_w1, B_b1, B_w2, B_b2):
    def _A_ref(x, wqkv, w_phi, wo):
        B, S, D = x.shape
        H = 16; Dh = D // H
        qkv = (lambda x, *d: x.permute(*d))((x @ wqkv).reshape(B, S, 3, H, Dh), 2, 0, 3, 1, 4)
        q, k, v = qkv[0], qkv[1], qkv[2]
        pq = torch.einsum("bhsd,hdf->bhsf", q, w_phi)
        pk = torch.einsum("bhsd,hdf->bhsf", k, w_phi)
        phi_q = torch.concatenate([_softmax(pq, axis=-1), _softmax(-pq, axis=-1)], axis=-1)
        phi_k = torch.concatenate([_softmax(pk, axis=-1), _softmax(-pk, axis=-1)], axis=-1)
        kv = torch.einsum("bhsf,bhsd->bhfd", phi_k, v)
        z  = torch.einsum("bhsf->bhf", phi_k)
        num = torch.einsum("bhqf,bhfd->bhqd", phi_q, kv)
        den = torch.einsum("bhqf,bhf->bhq", phi_q, z)[..., None] + 1e-6
        o = num / den
        return (lambda x, *d: x.permute(*d))(o, 0, 2, 1, 3).reshape(B, S, D) @ wo

    def _B_ref(x, w1, b1, w2, b2):
        B, S, D = x.shape
        h = _layernorm(x, axis=-1)
        u = torch.einsum("bsd,sf->bdf", h, w1) + b1
        u = _gelu(u)
        y = torch.einsum("bdf,fs->bds", u, w2) + b2
        return (lambda x, *d: x.permute(*d))(y, 0, 2, 1)

    x = A_x
    h = x + _A_ref(_layernorm(x, axis=-1), A_wqkv, A_w_phi, A_wo)
    h2 = h + _B_ref(_layernorm(h, axis=-1), B_w1, B_b1, B_w2, B_b2)
    return h2
```

```asm
; @launch grid=(256,1,1) block=(256,1,1) lds=163840
.amdgcn_target "amdgcn-amd-amdhsa--gfx950"
.text
.globl sequential_preLN__linear_kernel_hedgehog__mixer_token_mlp__prompt_kernel
.p2align 8
.type sequential_preLN__linear_kernel_hedgehog__mixer_token_mlp__prompt_kernel,@function
sequential_preLN__linear_kernel_hedgehog__mixer_token_mlp__prompt_kernel:
    s_cmp_ge_u32 s2, 0x100
    s_cbranch_scc1 L_end
    s_load_dwordx4 s[4:7], s[0:1], 8
    s_load_dwordx2 s[10:11], s[0:1], 24
    s_load_dwordx2 s[12:13], s[0:1], 0
    s_load_dwordx4 s[20:23], s[0:1], 80
    s_memrealtime s[58:59]
    v_lshrrev_b32 v23, 6, v0
    v_and_b32 v1, 63, v0
    v_readfirstlane_b32 s48, v23
    s_and_b32 s81, s2, 7
    s_lshr_b32 s82, s2, 3
    v_and_b32 v2, 31, v0
    s_and_b32 s53, s81, 3
    s_lshr_b32 s54, s82, 3
    s_lshl2_add_u32 s49, s53, s54
    s_lshr_b32 s97, s81, 2
    s_and_b32 s56, s82, 7
    s_lshl3_add_u32 s50, s97, s56
    v_lshrrev_b32 v30, 1, v2
    v_xor_b32 v30, v30, v2
    v_and_b32 v30, 4, v30
    v_mul_u32_u24 v30, 3, v30
    v_xor_b32 v184, v30, v2
    v_lshrrev_b32 v31, 5, v1
    v_lshlrev_b32 v3, 4, v1
    s_mul_i32 s55, s50, 56
    s_cmp_eq_u32 s48, 3
    s_cbranch_scc1 L_wo
    v_mul_u32_u24 v185, 2688, v184
    s_mul_i32 s88, s49, 86016
    s_add_u32 s88, s88, s55
    s_add_u32 s57, s48, 1
    s_mul_i32 s57, s57, 896
    s_cmp_eq_u32 s48, 2
    s_cselect_b32 s57, 0, s57
    s_add_u32 s88, s88, s57
    s_mov_b32 s89, 1204224
    s_branch L_wj
L_wo:
    v_lshrrev_b32 v185, 4, v2
    v_bfe_u32 v23, v2, 2, 1
    v_lshl_add_u32 v185, v185, 1, v23
    s_lshl_b32 s57, s49, 2
    v_add_u32 v185, s57, v185
    v_mul_u32_u24 v23, 37, v185
    v_lshrrev_b32 v23, 8, v23
    v_mul_u32_u24 v30, 7, v23
    v_sub_u32 v185, v185, v30
    v_lshlrev_b32 v185, 2, v185
    v_mov_b32 v30, 0x0b875410
    v_mov_b32 v186, 0x0da9c632
    v_and_b32 v187, 8, v2
    v_cmp_ne_u32 vcc, 0, v187
    s_nop 1
    v_cndmask_b32 v30, v30, v186, vcc
    v_bfe_u32 v185, v30, v185, 4
    v_mul_u32_u24 v23, 14, v23
    v_add_u32 v185, v185, v23
    v_and_b32 v23, 3, v2
    v_lshl_add_u32 v185, v185, 2, v23
    v_mul_u32_u24 v185, 896, v185
    s_mov_b32 s88, s55
    s_mov_b32 s89, 401408
L_wj:
    v_lshl_add_u32 v185, v31, 4, v185
    s_cmp_ge_u32 s49, 14
    s_cselect_b32 s91, 2147483648, 0
    s_or_b32 s88, s88, s91
    s_mul_i32 s57, s50, 1568
    s_lshl_b32 s55, s48, 31
    s_or_b32 s57, s57, s55
    s_lshl_b32 s90, s48, 11
    s_add_u32 m0, s90, 155648
    s_waitcnt lgkmcnt(0)
    s_mov_b64 s[8:9], s[6:7]
    s_cmp_eq_u32 s48, 3
    s_cselect_b64 s[4:5], s[10:11], s[4:5]
    s_mov_b32 s6, s89
    s_mov_b32 s7, 0x20000
    buffer_load_dwordx4 v[144:147], v185, s[4:7], s88 offen
    buffer_load_dwordx4 v[148:151], v185, s[4:7], s88 offen offset:24
    s_mov_b32 s10, 25088
    s_mov_b32 s11, 0x20000
    buffer_load_dwordx4 v3, s[8:11], s57 offen lds
    buffer_load_dwordx4 v3, s[8:11], s57 offen offset:1024 lds
    s_mov_b64 s[16:17], s[22:23]
    s_mov_b32 s22, 256
    s_mov_b32 s23, 0x20000
    s_or_b32 s55, s2, s48
    s_cmp_lg_u32 s55, 0
    s_cbranch_scc1 L_notag
    s_or_b32 s55, s58, 1
    v_mov_b32 v250, s55
    v_lshlrev_b32 v23, 25, v1
    buffer_store_dword v250, v23, s[20:23], 0 offen sc1
L_notag:
    s_add_u32 s51, s56, s54
    s_cmp_ge_u32 s51, 7
    s_cselect_b32 s55, 7, 0
    s_sub_u32 s51, s51, s55
    s_movk_i32 s87, 896
    s_mul_i32 s62, s48, 28672
    s_mov_b32 s14, 1835008
    s_mov_b32 s15, 0x20000
    s_lshl_b32 s53, s49, 7
    s_lshl_b32 s55, s48, 5
    s_add_u32 s53, s53, s55
    v_lshrrev_b32 v30, 3, v1
    v_add_u32 v30, s53, v30
    v_mul_u32_u24 v30, s87, v30
    v_lshrrev_b32 v8, 4, v1
    v_and_b32 v23, 7, v1
    v_xor_b32 v23, v8, v23
    v_lshlrev_b32 v23, 4, v23
    v_add_u32 v5, v30, v23
    v_xor_b32 v23, 64, v23
    v_add_u32 v6, v30, v23
    v_add_u32 v6, 6144, v6
    v_add_u32 v7, 12288, v5
    v_add_u32 v8, 12288, v6
    s_lshl_b32 s64, s51, 7
    s_add_u32 s65, s64, 128
    s_cmp_eq_u32 s65, 896
    s_cselect_b32 s65, 0, s65
    s_add_u32 s66, s65, 128
    s_cmp_eq_u32 s66, 896
    s_cselect_b32 s66, 0, s66
    s_add_u32 s67, s66, 128
    s_cmp_eq_u32 s67, 896
    s_cselect_b32 s67, 0, s67
    s_add_u32 s68, s67, 128
    s_cmp_eq_u32 s68, 896
    s_cselect_b32 s68, 0, s68
    s_add_u32 s69, s68, 128
    s_cmp_eq_u32 s69, 896
    s_cselect_b32 s69, 0, s69
    s_add_u32 s70, s69, 128
    s_cmp_eq_u32 s70, 896
    s_cselect_b32 s70, 0, s70
    s_add_u32 m0, s62, 0
    s_nop 0
    buffer_load_dwordx4 v5, s[12:15], s64 offen offset:0 lds
    buffer_load_dwordx4 v6, s[12:15], s64 offen offset:1024 lds
    buffer_load_dwordx4 v7, s[12:15], s64 offen offset:2048 lds
    buffer_load_dwordx4 v8, s[12:15], s64 offen offset:3072 lds
    s_getpc_b64 s[44:45]
L_pc:
    s_mov_b32 s46, L_fin-L_pc
    s_mov_b32 s47, 0x20000
    s_lshl2_add_u32 s53, s56, s48
    s_mul_i32 s53, s53, 1280
    v_min_u32 v23, 9, v1
    v_lshlrev_b32 v23, 7, v23
    buffer_load_dword v188, v23, s[44:47], s53 offen
    s_mov_b32 s18, 268435456
    s_mov_b32 s19, 0x20000
    s_mov_b32 s60, 0
    s_mov_b32 s61, -1
    s_mov_b32 s78, 0
    v_lshlrev_b32 v23, 2, v31
    v_sub_u32 v23, v2, v23
    v_and_b32 v30, 1, v23
    v_lshlrev_b32 v30, 4, v30
    v_mov_b32 v25, 0x3f80
    v_lshlrev_b32 v30, v30, v25
    v_ashrrev_i32 v23, 1, v23
    v_cmp_eq_u32 vcc, 0, v23
    v_cmp_eq_u32 s[98:99], 1, v23
    s_nop 0
    v_cndmask_b32 v240, 0, v30, vcc
    v_cndmask_b32 v241, 0, v30, s[98:99]
    v_cmp_eq_u32 vcc, 4, v23
    v_cmp_eq_u32 s[98:99], 5, v23
    s_nop 0
    v_cndmask_b32 v242, 0, v30, vcc
    v_cndmask_b32 v243, 0, v30, s[98:99]
    v_cmp_eq_u32 vcc, 8, v23
    v_cmp_eq_u32 s[98:99], 9, v23
    s_nop 0
    v_cndmask_b32 v244, 0, v30, vcc
    v_cndmask_b32 v245, 0, v30, s[98:99]
    v_cmp_eq_u32 vcc, 12, v23
    v_cmp_eq_u32 s[98:99], 13, v23
    s_nop 0
    v_cndmask_b32 v246, 0, v30, vcc
    v_cndmask_b32 v247, 0, v30, s[98:99]
    v_lshrrev_b32 v23, 4, v2
    v_lshlrev_b32 v30, 2, v23
    v_sub_u32 v187, v184, v30
    v_mul_u32_u24 v27, 448, v31
    v_lshl_add_u32 v186, v187, 4, v27
    v_lshlrev_b32 v187, 2, v187
    v_bfe_u32 v30, v1, 2, 2
    v_lshl_add_u32 v30, v31, 3, v30
    v_mul_u32_u24 v30, 56, v30
    v_mul_u32_u24 v23, 24, v23
    v_and_b32 v25, 1, v1
    v_lshl_add_u32 v23, v25, 4, v23
    v_and_b32 v25, 2, v1
    v_lshl_add_u32 v23, v25, 2, v23
    s_add_u32 s53, s90, 155648
    v_add3_u32 v184, v30, v23, s53
    v_mov_b32 v248, 0x3f803f80
    v_mov_b32 v252, 0
    s_lshl4_add_u32 s92, s50, s49
    s_lshl_b32 s92, s92, 2
    s_add_u32 s92, s92, s48
    s_lshl_b32 s92, s92, 7
    s_or_b32 s92, s92, s91
    s_lshl2_add_u32 s53, s50, s48
    s_mul_i32 s53, s53, 14
    s_add_u32 s53, s53, s49
    s_lshl_b32 s53, s53, 11
    s_add_u32 s53, s53, 1048576
    s_or_b32 s91, s91, s53
    v_mov_b32 v250, 0
    buffer_load_dword v250, v250, s[20:23], 0 offen sc1
    s_waitcnt vmcnt(6)
    ds_read_b64_tr_b16 v[152:153], v184 offset:0
    ds_read_b64_tr_b16 v[154:155], v184 offset:224
    ds_read_b64_tr_b16 v[156:157], v184 offset:672
    ds_read_b64_tr_b16 v[158:159], v184 offset:896
    s_waitcnt lgkmcnt(0)
    v_cndmask_b32 v156, 0, v156, s[60:61]
    v_cndmask_b32 v157, 0, v157, s[60:61]
    s_bitcmp1_b32 s48, 0
    s_cbranch_scc0 L_bphi
    v_mov_b32 v152, v240
    v_mov_b32 v153, v241
    v_mov_b32 v154, v242
    v_mov_b32 v155, v243
    v_mov_b32 v156, v244
    v_mov_b32 v157, v245
    v_mov_b32 v158, v246
    v_mov_b32 v159, v247
L_bphi:
    v_mfma_f32_32x32x16_bf16 v[160:175], v[144:147], v[152:155], 0
    s_nop 0
    v_mfma_f32_32x32x16_bf16 v[160:175], v[148:151], v[156:159], v[160:175]
    v_cmp_lt_u32 vcc, 27, v2
    v_lshl_add_u32 v13, v2, 4, v27
    v_mov_b32 v23, 2147483648
    v_cndmask_b32 v4, v13, v23, vcc
    v_subrev_u32 v30, 64, v13
    v_cndmask_b32 v13, v13, v30, vcc
    v_add_u32 v14, 114688, v13
    s_lshl_b32 s63, s48, 10
    v_lshlrev_b32 v0, 2, v2
    v_and_b32 v30, 3, v1
    v_lshl_add_u32 v30, v30, 2, 64
    v_add_u32 v30, 48, v30
    v_cndmask_b32 v187, v187, v30, s[60:61]
    v_cvt_pk_bf16_f32 v176, v160, v161
    v_cvt_pk_bf16_f32 v177, v162, v163
    v_cvt_pk_bf16_f32 v178, v164, v165
    v_cvt_pk_bf16_f32 v179, v166, v167
    buffer_store_dwordx4 v[176:179], v186, s[16:19], s91 offen sc1
    v_cvt_pk_bf16_f32 v180, v168, v169
    v_cvt_pk_bf16_f32 v181, v170, v171
    v_cvt_pk_bf16_f32 v182, v172, v173
    v_cvt_pk_bf16_f32 v183, v174, v175
    buffer_store_dwordx4 v[180:183], v186, s[16:19], s91 offen offset:896 sc1
    v_dot2c_f32_bf16 v252, v248, v176
    v_dot2c_f32_bf16 v252, v248, v177
    v_dot2c_f32_bf16 v252, v248, v178
    v_dot2c_f32_bf16 v252, v248, v179
    v_dot2c_f32_bf16 v252, v248, v180
    v_dot2c_f32_bf16 v252, v248, v181
    v_dot2c_f32_bf16 v252, v248, v182
    v_dot2c_f32_bf16 v252, v248, v183
    s_nop 2
    v_mov_b32 v23, v252
    s_nop 1
    v_permlane32_swap_b32 v252, v23
    v_add_f32 v23, v252, v23
    buffer_store_dword v23, v187, s[16:19], s91 offen offset:1792 sc1
    s_load_dwordx2 s[24:25], s[0:1], 40
    s_add_u32 m0, s62, 4096
    s_nop 0
    buffer_load_dwordx4 v5, s[12:15], s65 offen offset:0 lds
    s_load_dwordx2 s[32:33], s[0:1], 48
    buffer_load_dwordx4 v6, s[12:15], s65 offen offset:1024 lds
    s_load_dwordx2 s[28:29], s[0:1], 56
    buffer_load_dwordx4 v7, s[12:15], s65 offen offset:2048 lds
    s_load_dwordx2 s[36:37], s[0:1], 64
    buffer_load_dwordx4 v8, s[12:15], s65 offen offset:3072 lds
    s_load_dwordx2 s[40:41], s[0:1], 72
    s_add_u32 m0, s62, 8192
    s_nop 0
    buffer_load_dwordx4 v5, s[12:15], s66 offen offset:0 lds
    v_bfe_u32 v30, v1, 1, 3
    buffer_load_dwordx4 v6, s[12:15], s66 offen offset:1024 lds
    v_xor_b32 v30, v30, v31
    v_lshlrev_b32 v30, 4, v30
    buffer_load_dwordx4 v7, s[12:15], s66 offen offset:2048 lds
    v_lshlrev_b32 v23, 7, v2
    v_add_u32 v23, s62, v23
    v_xor_b32 v9, 0, v30
    v_add_u32 v9, v9, v23
    v_xor_b32 v10, 32, v30
    v_add_u32 v10, v10, v23
    v_xor_b32 v11, 64, v30
    v_add_u32 v11, v11, v23
    v_xor_b32 v12, 96, v30
    buffer_load_dwordx4 v8, s[12:15], s66 offen offset:3072 lds
    v_add_u32 v12, v12, v23
    v_mov_b32 v252, 0
    v_mov_b32 v253, 0
    v_mov_b32 v254, 0
    v_mov_b32 v255, 0
    v_accvgpr_write_b32 a252, -1
    v_accvgpr_write_b32 a253, -1
    v_accvgpr_write_b32 a254, -1
    v_accvgpr_write_b32 a255, -1
    s_add_u32 m0, s62, 12288
    s_nop 0
    buffer_load_dwordx4 v5, s[12:15], s67 offen offset:0 lds
    s_lshr_b32 s57, s56, 2
    s_lshl1_add_u32 s57, s97, s57
    s_lshl2_add_u32 s79, s49, s57
    s_and_b32 s80, s82, 3
    s_mul_i32 s83, s82, 37
    s_lshr_b32 s83, s83, 8
    s_lshr_b32 s85, s82, 3
    s_mul_i32 s55, s83, 7
    s_sub_u32 s55, s82, s55
    s_and_b32 s53, s81, 3
    buffer_load_dwordx4 v6, s[12:15], s67 offen offset:1024 lds
    s_mul_i32 s84, s53, 7
    s_add_u32 s84, s84, s55
    s_lshl3_add_u32 s86, s53, s56
    s_mul_i32 s53, s50, 114688
    s_add_u32 s53, s53, s63
    s_add_u32 s53, s53, 1048576
    s_lshl_b32 s71, s64, 5
    s_add_u32 s71, s71, s53
    s_lshl_b32 s72, s65, 5
    s_add_u32 s72, s72, s53
    s_lshl_b32 s73, s66, 5
    buffer_load_dwordx4 v7, s[12:15], s67 offen offset:2048 lds
    s_add_u32 s73, s73, s53
    s_lshl_b32 s74, s67, 5
    s_add_u32 s74, s74, s53
    s_lshl_b32 s75, s68, 5
    s_add_u32 s75, s75, s53
    s_lshl_b32 s76, s69, 5
    s_add_u32 s76, s76, s53
    s_lshl_b32 s77, s70, 5
    s_add_u32 s77, s77, s53
    s_and_b32 s55, s48, 1
    s_lshl_b32 s55, s55, 31
    buffer_load_dwordx4 v8, s[12:15], s67 offen offset:3072 lds
    v_cmp_lt_u32 vcc, 55, v1
    v_mov_b32 v23, s55
    s_nop 0
    v_cndmask_b32 v23, 0, v23, vcc
    v_or_b32 v192, v3, v23
    v_add_u32 v193, 28672, v192
    v_bfe_u32 v23, v1, 2, 2
    v_lshlrev_b32 v23, 2, v23
    v_add_u32 v23, s48, v23
    v_min_u32 v23, 13, v23
    v_and_b32 v30, 3, v1
    v_min_u32 v30, 2, v30
    v_lshlrev_b32 v30, 7, v30
    v_lshl_add_u32 v195, v23, 9, v30
    s_lshl4_add_u32 s53, s50, s49
    s_lshl2_add_u32 s53, s53, s48
    s_lshl_b32 s53, s53, 10
    s_add_u32 s93, s53, 2883584
    s_lshl2_add_u32 s53, s49, s48
    s_mul_i32 s53, s53, 28672
    s_lshr_b32 s55, s50, 1
    s_mul_i32 s55, s55, 3584
    s_add_u32 s53, s53, s55
    s_add_u32 s94, s53, 3932160
    s_and_b32 s55, s50, 1
    s_lshl_b32 s57, s55, 11
    s_lshl3_add_u32 s55, s55, 1024
    v_add_u32 v238, s57, v3
    v_mov_b32 v23, 2147483648
    v_add_u32 v239, 1024, v238
    v_cndmask_b32 v239, v239, v23, s[60:61]
    v_add_u32 v249, s55, v3
    v_cndmask_b32 v249, v23, v249, s[60:61]
    s_lshl_b32 s57, s57, 20
    v_or_b32 v197, s57, v249
    s_lshl2_add_u32 s100, s80, s48
    s_lshl_b32 s53, s100, 6
    s_add_u32 s53, s53, s79
    s_mul_i32 s53, s53, 1792
    s_add_u32 s95, s53, 5767168
    s_lshl1_add_u32 s53, s83, s97
    s_mul_i32 s53, s53, 56
    s_add_u32 s53, s53, s84
    s_lshl2_add_u32 s53, s53, s48
    s_mul_i32 s53, s53, 896
    s_add_u32 s96, s53, 9437184
    s_cmp_ge_u32 s82, 28
    s_cselect_b32 s96, 2147483648, s96
    s_waitcnt vmcnt(17)
    ds_read_b128 v[32:35], v9 offset:0
    ds_read_b128 v[36:39], v10 offset:0
    ds_read_b128 v[40:43], v11 offset:0
    ds_read_b128 v[44:47], v12 offset:0
    s_waitcnt vmcnt(8)
    ds_read_b128 v[48:51], v9 offset:4096
    ds_read_b128 v[52:55], v10 offset:4096
    ds_read_b128 v[56:59], v11 offset:4096
    ds_read_b128 v[60:63], v12 offset:4096
    s_waitcnt lgkmcnt(7)
    v_dot2c_f32_bf16 v252, v248, v32
    v_dot2c_f32_bf16 v254, v32, v32
    v_dot2c_f32_bf16 v253, v248, v33
    v_dot2c_f32_bf16 v255, v33, v33
    v_dot2c_f32_bf16 v252, v248, v34
    v_dot2c_f32_bf16 v254, v34, v34
    v_dot2c_f32_bf16 v253, v248, v35
    v_dot2c_f32_bf16 v255, v35, v35
    s_waitcnt lgkmcnt(6)
    v_dot2c_f32_bf16 v252, v248, v36
    v_dot2c_f32_bf16 v254, v36, v36
    v_dot2c_f32_bf16 v253, v248, v37
    v_dot2c_f32_bf16 v255, v37, v37
    v_dot2c_f32_bf16 v252, v248, v38
    v_dot2c_f32_bf16 v254, v38, v38
    v_dot2c_f32_bf16 v253, v248, v39
    v_dot2c_f32_bf16 v255, v39, v39
    s_waitcnt lgkmcnt(5)
    v_dot2c_f32_bf16 v252, v248, v40
    v_dot2c_f32_bf16 v254, v40, v40
    v_dot2c_f32_bf16 v253, v248, v41
    v_dot2c_f32_bf16 v255, v41, v41
    v_dot2c_f32_bf16 v252, v248, v42
    v_dot2c_f32_bf16 v254, v42, v42
    v_dot2c_f32_bf16 v253, v248, v43
    v_dot2c_f32_bf16 v255, v43, v43
    s_waitcnt lgkmcnt(4)
    v_dot2c_f32_bf16 v252, v248, v44
    v_dot2c_f32_bf16 v254, v44, v44
    v_dot2c_f32_bf16 v253, v248, v45
    v_dot2c_f32_bf16 v255, v45, v45
    v_dot2c_f32_bf16 v252, v248, v46
    v_dot2c_f32_bf16 v254, v46, v46
    v_dot2c_f32_bf16 v253, v248, v47
    v_dot2c_f32_bf16 v255, v47, v47
tagp_1:
    v_readfirstlane_b32 s52, v250
    s_nop 0
    s_cmp_lg_u32 s52, 0
    s_cbranch_scc1 tagd_2
    v_mov_b32 v250, 0
    buffer_load_dword v250, v250, s[20:23], 0 offen sc1
    s_waitcnt vmcnt(0)
    s_add_u32 s78, s78, 1
    s_cmp_lt_u32 s78, 0x8000
    s_cbranch_scc1 tagp_1
tagd_2:
    buffer_store_dword v250, v0, s[16:19], s92 offen sc1
    s_lshl_b32 s92, s50, 13
    s_waitcnt vmcnt(5)
    s_add_u32 m0, s62, 16384
    s_nop 0
    buffer_load_dwordx4 v5, s[12:15], s68 offen offset:0 lds
    ds_read_b128 v[64:67], v9 offset:8192
    buffer_load_dwordx4 v6, s[12:15], s68 offen offset:1024 lds
    ds_read_b128 v[68:71], v10 offset:8192
    ds_read_b128 v[72:75], v11 offset:8192
    buffer_load_dwordx4 v7, s[12:15], s68 offen offset:2048 lds
    ds_read_b128 v[76:79], v12 offset:8192
    s_waitcnt lgkmcnt(7)
    v_dot2c_f32_bf16 v252, v248, v48
    v_dot2c_f32_bf16 v254, v48, v48
    v_dot2c_f32_bf16 v253, v248, v49
    v_dot2c_f32_bf16 v255, v49, v49
    v_dot2c_f32_bf16 v252, v248, v50
    v_dot2c_f32_bf16 v254, v50, v50
    buffer_load_dwordx4 v8, s[12:15], s68 offen offset:3072 lds
    v_dot2c_f32_bf16 v253, v248, v51
    v_dot2c_f32_bf16 v255, v51, v51
    s_waitcnt lgkmcnt(6)
    v_dot2c_f32_bf16 v252, v248, v52
    v_dot2c_f32_bf16 v254, v52, v52
    v_dot2c_f32_bf16 v253, v248, v53
    v_dot2c_f32_bf16 v255, v53, v53
    v_dot2c_f32_bf16 v252, v248, v54
    s_add_u32 m0, s62, 20480
    s_nop 0
    buffer_load_dwordx4 v5, s[12:15], s69 offen offset:0 lds
    v_dot2c_f32_bf16 v254, v54, v54
    v_dot2c_f32_bf16 v253, v248, v55
    v_dot2c_f32_bf16 v255, v55, v55
    s_waitcnt lgkmcnt(5)
    v_dot2c_f32_bf16 v252, v248, v56
    v_dot2c_f32_bf16 v254, v56, v56
    v_dot2c_f32_bf16 v253, v248, v57
    buffer_load_dwordx4 v6, s[12:15], s69 offen offset:1024 lds
    v_dot2c_f32_bf16 v255, v57, v57
    v_dot2c_f32_bf16 v252, v248, v58
    v_dot2c_f32_bf16 v254, v58, v58
    v_dot2c_f32_bf16 v253, v248, v59
    v_dot2c_f32_bf16 v255, v59, v59
    s_waitcnt lgkmcnt(4)
    v_dot2c_f32_bf16 v252, v248, v60
    v_dot2c_f32_bf16 v254, v60, v60
    buffer_load_dwordx4 v7, s[12:15], s69 offen offset:2048 lds
    v_dot2c_f32_bf16 v253, v248, v61
    v_dot2c_f32_bf16 v255, v61, v61
    v_dot2c_f32_bf16 v252, v248, v62
    v_dot2c_f32_bf16 v254, v62, v62
    v_dot2c_f32_bf16 v253, v248, v63
    v_dot2c_f32_bf16 v255, v63, v63
    s_waitcnt vmcnt(8)
    buffer_load_dwordx4 v8, s[12:15], s69 offen offset:3072 lds
    ds_read_b128 v[80:83], v9 offset:12288
    s_add_u32 m0, s62, 24576
    s_nop 0
    buffer_load_dwordx4 v5, s[12:15], s70 offen offset:0 lds
    ds_read_b128 v[84:87], v10 offset:12288
    ds_read_b128 v[88:91], v11 offset:12288
    buffer_load_dwordx4 v6, s[12:15], s70 offen offset:1024 lds
    ds_read_b128 v[92:95], v12 offset:12288
    s_waitcnt lgkmcnt(7)
    v_dot2c_f32_bf16 v252, v248, v64
    v_dot2c_f32_bf16 v254, v64, v64
    v_dot2c_f32_bf16 v253, v248, v65
    v_dot2c_f32_bf16 v255, v65, v65
    v_dot2c_f32_bf16 v252, v248, v66
    v_dot2c_f32_bf16 v254, v66, v66
    buffer_load_dwordx4 v7, s[12:15], s70 offen offset:2048 lds
    v_dot2c_f32_bf16 v253, v248, v67
    v_dot2c_f32_bf16 v255, v67, v67
    s_waitcnt lgkmcnt(6)
    v_dot2c_f32_bf16 v252, v248, v68
    v_dot2c_f32_bf16 v254, v68, v68
    v_dot2c_f32_bf16 v253, v248, v69
    v_dot2c_f32_bf16 v255, v69, v69
    v_dot2c_f32_bf16 v252, v248, v70
    buffer_load_dwordx4 v8, s[12:15], s70 offen offset:3072 lds
    v_dot2c_f32_bf16 v254, v70, v70
    v_dot2c_f32_bf16 v253, v248, v71
    v_dot2c_f32_bf16 v255, v71, v71
    s_waitcnt lgkmcnt(5)
    v_dot2c_f32_bf16 v252, v248, v72
    v_dot2c_f32_bf16 v254, v72, v72
    v_dot2c_f32_bf16 v253, v248, v73
    v_dot2c_f32_bf16 v255, v73, v73
    v_dot2c_f32_bf16 v252, v248, v74
    v_dot2c_f32_bf16 v254, v74, v74
    v_dot2c_f32_bf16 v253, v248, v75
    v_dot2c_f32_bf16 v255, v75, v75
    s_waitcnt lgkmcnt(4)
    v_dot2c_f32_bf16 v252, v248, v76
    v_dot2c_f32_bf16 v254, v76, v76
    v_dot2c_f32_bf16 v253, v248, v77
    v_dot2c_f32_bf16 v255, v77, v77
    v_dot2c_f32_bf16 v252, v248, v78
    v_dot2c_f32_bf16 v254, v78, v78
    v_dot2c_f32_bf16 v253, v248, v79
    v_dot2c_f32_bf16 v255, v79, v79
    s_waitcnt vmcnt(8)
    ds_read_b128 v[96:99], v9 offset:16384
    ds_read_b128 v[100:103], v10 offset:16384
    ds_read_b128 v[104:107], v11 offset:16384
    ds_read_b128 v[108:111], v12 offset:16384
    s_waitcnt lgkmcnt(7)
    v_dot2c_f32_bf16 v252, v248, v80
    v_dot2c_f32_bf16 v254, v80, v80
    v_dot2c_f32_bf16 v253, v248, v81
    v_dot2c_f32_bf16 v255, v81, v81
    v_dot2c_f32_bf16 v252, v248, v82
    v_dot2c_f32_bf16 v254, v82, v82
    v_dot2c_f32_bf16 v253, v248, v83
    v_dot2c_f32_bf16 v255, v83, v83
    s_waitcnt lgkmcnt(6)
    v_dot2c_f32_bf16 v252, v248, v84
    v_dot2c_f32_bf16 v254, v84, v84
    v_dot2c_f32_bf16 v253, v248, v85
    v_dot2c_f32_bf16 v255, v85, v85
    v_dot2c_f32_bf16 v252, v248, v86
    v_dot2c_f32_bf16 v254, v86, v86
    v_dot2c_f32_bf16 v253, v248, v87
    v_dot2c_f32_bf16 v255, v87, v87
    s_waitcnt lgkmcnt(5)
    v_dot2c_f32_bf16 v252, v248, v88
    v_dot2c_f32_bf16 v254, v88, v88
    v_dot2c_f32_bf16 v253, v248, v89
    v_dot2c_f32_bf16 v255, v89, v89
    v_dot2c_f32_bf16 v252, v248, v90
    v_dot2c_f32_bf16 v254, v90, v90
    v_dot2c_f32_bf16 v253, v248, v91
    v_dot2c_f32_bf16 v255, v91, v91
    s_waitcnt lgkmcnt(4)
    v_dot2c_f32_bf16 v252, v248, v92
    v_dot2c_f32_bf16 v254, v92, v92
    v_dot2c_f32_bf16 v253, v248, v93
    v_dot2c_f32_bf16 v255, v93, v93
    v_dot2c_f32_bf16 v252, v248, v94
    v_dot2c_f32_bf16 v254, v94, v94
    v_dot2c_f32_bf16 v253, v248, v95
    v_dot2c_f32_bf16 v255, v95, v95
    s_waitcnt vmcnt(4)
    ds_read_b128 v[112:115], v9 offset:20480
    ds_read_b128 v[116:119], v10 offset:20480
    ds_read_b128 v[120:123], v11 offset:20480
    ds_read_b128 v[124:127], v12 offset:20480
    s_waitcnt lgkmcnt(7)
    v_dot2c_f32_bf16 v252, v248, v96
    v_dot2c_f32_bf16 v254, v96, v96
    v_dot2c_f32_bf16 v253, v248, v97
    v_dot2c_f32_bf16 v255, v97, v97
    v_dot2c_f32_bf16 v252, v248, v98
    v_dot2c_f32_bf16 v254, v98, v98
    v_dot2c_f32_bf16 v253, v248, v99
    v_dot2c_f32_bf16 v255, v99, v99
    s_waitcnt lgkmcnt(6)
    v_dot2c_f32_bf16 v252, v248, v100
    v_dot2c_f32_bf16 v254, v100, v100
    v_dot2c_f32_bf16 v253, v248, v101
    v_dot2c_f32_bf16 v255, v101, v101
    v_dot2c_f32_bf16 v252, v248, v102
    v_dot2c_f32_bf16 v254, v102, v102
    v_dot2c_f32_bf16 v253, v248, v103
    v_dot2c_f32_bf16 v255, v103, v103
    s_waitcnt lgkmcnt(5)
    v_dot2c_f32_bf16 v252, v248, v104
    v_dot2c_f32_bf16 v254, v104, v104
    v_dot2c_f32_bf16 v253, v248, v105
    v_dot2c_f32_bf16 v255, v105, v105
    v_dot2c_f32_bf16 v252, v248, v106
    v_dot2c_f32_bf16 v254, v106, v106
    v_dot2c_f32_bf16 v253, v248, v107
    v_dot2c_f32_bf16 v255, v107, v107
    s_waitcnt lgkmcnt(4)
    v_dot2c_f32_bf16 v252, v248, v108
    v_dot2c_f32_bf16 v254, v108, v108
    v_dot2c_f32_bf16 v253, v248, v109
    v_dot2c_f32_bf16 v255, v109, v109
    v_dot2c_f32_bf16 v252, v248, v110
    v_dot2c_f32_bf16 v254, v110, v110
    v_dot2c_f32_bf16 v253, v248, v111
    v_dot2c_f32_bf16 v255, v111, v111
    s_waitcnt vmcnt(0)
    ds_read_b128 v[128:131], v9 offset:24576
    ds_read_b128 v[132:135], v10 offset:24576
    ds_read_b128 v[136:139], v11 offset:24576
    ds_read_b128 v[140:143], v12 offset:24576
    s_waitcnt lgkmcnt(7)
    v_dot2c_f32_bf16 v252, v248, v112
    v_dot2c_f32_bf16 v254, v112, v112
    v_dot2c_f32_bf16 v253, v248, v113
    v_dot2c_f32_bf16 v255, v113, v113
    v_dot2c_f32_bf16 v252, v248, v114
    v_dot2c_f32_bf16 v254, v114, v114
    v_dot2c_f32_bf16 v253, v248, v115
    v_dot2c_f32_bf16 v255, v115, v115
    s_waitcnt lgkmcnt(6)
    v_dot2c_f32_bf16 v252, v248, v116
    v_dot2c_f32_bf16 v254, v116, v116
    v_dot2c_f32_bf16 v253, v248, v117
    v_dot2c_f32_bf16 v255, v117, v117
    v_dot2c_f32_bf16 v252, v248, v118
    v_dot2c_f32_bf16 v254, v118, v118
    v_dot2c_f32_bf16 v253, v248, v119
    v_dot2c_f32_bf16 v255, v119, v119
    s_waitcnt lgkmcnt(5)
    v_dot2c_f32_bf16 v252, v248, v120
    v_dot2c_f32_bf16 v254, v120, v120
    v_dot2c_f32_bf16 v253, v248, v121
    v_dot2c_f32_bf16 v255, v121, v121
    v_dot2c_f32_bf16 v252, v248, v122
    v_dot2c_f32_bf16 v254, v122, v122
    v_dot2c_f32_bf16 v253, v248, v123
    v_dot2c_f32_bf16 v255, v123, v123
    s_waitcnt lgkmcnt(4)
    v_dot2c_f32_bf16 v252, v248, v124
    v_dot2c_f32_bf16 v254, v124, v124
    v_dot2c_f32_bf16 v253, v248, v125
    v_dot2c_f32_bf16 v255, v125, v125
    v_dot2c_f32_bf16 v252, v248, v126
    v_dot2c_f32_bf16 v254, v126, v126
    v_dot2c_f32_bf16 v253, v248, v127
    v_dot2c_f32_bf16 v255, v127, v127
    buffer_load_dword v196, v195, s[16:19], s92 offen sc1
    s_waitcnt lgkmcnt(3)
    v_dot2c_f32_bf16 v252, v248, v128
    v_dot2c_f32_bf16 v254, v128, v128
    v_dot2c_f32_bf16 v253, v248, v129
    v_dot2c_f32_bf16 v255, v129, v129
    v_dot2c_f32_bf16 v252, v248, v130
    v_dot2c_f32_bf16 v254, v130, v130
    v_dot2c_f32_bf16 v253, v248, v131
    v_dot2c_f32_bf16 v255, v131, v131
    s_waitcnt lgkmcnt(2)
    v_dot2c_f32_bf16 v252, v248, v132
    v_dot2c_f32_bf16 v254, v132, v132
    v_dot2c_f32_bf16 v253, v248, v133
    v_dot2c_f32_bf16 v255, v133, v133
    v_dot2c_f32_bf16 v252, v248, v134
    v_dot2c_f32_bf16 v254, v134, v134
    v_dot2c_f32_bf16 v253, v248, v135
    v_dot2c_f32_bf16 v255, v135, v135
    s_waitcnt lgkmcnt(1)
    v_dot2c_f32_bf16 v252, v248, v136
    v_dot2c_f32_bf16 v254, v136, v136
    v_dot2c_f32_bf16 v253, v248, v137
    v_dot2c_f32_bf16 v255, v137, v137
    v_dot2c_f32_bf16 v252, v248, v138
    v_dot2c_f32_bf16 v254, v138, v138
    v_dot2c_f32_bf16 v253, v248, v139
    v_dot2c_f32_bf16 v255, v139, v139
    s_waitcnt lgkmcnt(0)
    v_dot2c_f32_bf16 v252, v248, v140
    v_dot2c_f32_bf16 v254, v140, v140
    v_dot2c_f32_bf16 v253, v248, v141
    v_dot2c_f32_bf16 v255, v141, v141
    v_dot2c_f32_bf16 v252, v248, v142
    v_dot2c_f32_bf16 v254, v142, v142
    v_dot2c_f32_bf16 v253, v248, v143
    v_dot2c_f32_bf16 v255, v143, v143
    s_waitcnt vmcnt(0)
    v_cmp_ne_u32 vcc, s52, v196
    s_nop 0
    s_cbranch_vccnz re_3
bk_4:
    s_barrier
    s_add_u32 m0, s63, 114688
    s_nop 0
    buffer_load_dwordx4 v192, s[16:19], s71 offen sc1 lds
    s_add_u32 m0, s63, 118784
    s_nop 0
    buffer_load_dwordx4 v192, s[16:19], s72 offen sc1 lds
    s_add_u32 m0, s63, 122880
    s_nop 0
    buffer_load_dwordx4 v192, s[16:19], s73 offen sc1 lds
    s_add_u32 m0, s63, 126976
    s_nop 0
    buffer_load_dwordx4 v192, s[16:19], s74 offen sc1 lds
    s_add_u32 m0, s63, 131072
    s_nop 0
    buffer_load_dwordx4 v192, s[16:19], s75 offen sc1 lds
    s_add_u32 m0, s63, 135168
    s_nop 0
    buffer_load_dwordx4 v192, s[16:19], s76 offen sc1 lds
    s_add_u32 m0, s63, 139264
    s_nop 0
    buffer_load_dwordx4 v192, s[16:19], s77 offen sc1 lds
    v_add_u32 v7, 57344, v192
    v_add_f32 v252, v252, v253
    v_add_f32 v254, v254, v255
    v_mov_b32 v30, v252
    v_mov_b32 v23, v254
    s_nop 0
    v_permlane32_swap_b32 v252, v30
    v_permlane32_swap_b32 v254, v23
    v_add_f32 v252, v252, v30
    v_add_f32 v254, v254, v23
    v_mul_f32 v24, 0xbb124925, v252
    v_mul_f32 v30, v24, v24
    v_mov_b32 v23, 0x3b124925
    v_fma_f32 v30, v254, v23, -v30
    v_max_f32 v30, 0, v30
    v_add_f32 v30, 0x3727c5ac, v30
    v_rsq_f32 v28, v30
    s_nop 0
    v_mul_f32 v26, 0x3fb8aa3b, v28
    v_subrev_u32 v23, 4, v2
    v_cmp_lt_u32 vcc, 27, v2
    s_nop 1
    v_cndmask_b32 v23, v2, v23, vcc
    v_mul_u32_u24 v30, 14336, v31
    v_lshl_add_u32 v15, v23, 2, v30
    v_add_u32 v15, 1792, v15
    v_add_u32 v16, 114688, v15
    s_mul_i32 s53, s48, 384
    s_add_u32 s53, s53, 83968
    v_lshlrev_b32 v17, 2, v2
    v_add_u32 v17, s53, v17
    v_lshlrev_b32 v18, 4, v31
    v_add_u32 v18, s53, v18
    v_and_b32 v23, 15, v1
    s_add_u32 m0, s63, 0
    s_nop 0
    buffer_load_dwordx4 v193, s[16:19], s71 offen sc1 lds
    v_min_u32 v23, 13, v23
    v_lshlrev_b32 v195, 9, v23
    s_lshl_b32 s92, s100, 13
    s_add_u32 s92, s92, 384
    s_mul_i32 s100, s100, 114688
    s_add_u32 s100, s100, 1134592
    s_lshl_b32 s56, s2, 7
    s_add_u32 s56, s56, 131072
    s_cmp_eq_u32 s48, 0
    s_cselect_b32 s56, s56, 2147483648
    v_and_b32 v23, 15, v1
    s_add_u32 m0, s63, 4096
    s_nop 0
    buffer_load_dwordx4 v193, s[16:19], s72 offen sc1 lds
    v_lshrrev_b32 v30, 2, v23
    v_and_b32 v25, 3, v23
    v_lshl_add_u32 v30, v25, 6, v30
    s_and_b32 s53, s2, 0x3c
    v_add_u32 v30, s53, v30
    v_lshrrev_b32 v25, 3, v23
    v_lshlrev_b32 v25, 2, v25
    v_and_b32 v23, 7, v23
    v_lshl_add_u32 v25, v23, 3, v25
    s_and_b32 s53, s2, 0xc3
    s_add_u32 m0, s63, 8192
    s_nop 0
    buffer_load_dwordx4 v193, s[16:19], s73 offen sc1 lds
    v_add_u32 v25, s53, v25
    v_cmp_lt_u32 vcc, 15, v2
    s_nop 1
    v_cndmask_b32 v30, v30, v25, vcc
    v_lshlrev_b32 v5, 7, v30
    s_lshl_b32 s53, s48, 5
    v_add_u32 v23, s53, v2
    v_mul_u32_u24 v19, 136, v23
    v_mul_u32_u24 v20, 72, v23
    v_lshlrev_b32 v23, 3, v31
    v_add_u32 v19, v19, v23
    s_add_u32 m0, s63, 12288
    s_nop 0
    buffer_load_dwordx4 v193, s[16:19], s74 offen sc1 lds
    v_add_u32 v19, 57344, v19
    v_add_u32 v20, v20, v23
    v_add_u32 v20, 74752, v20
    v_bfe_u32 v30, v1, 2, 2
    v_lshrrev_b32 v23, 4, v1
    v_lshl_add_u32 v30, v23, 3, v30
    v_and_b32 v23, 3, v1
    v_lshlrev_b32 v23, 3, v23
    v_mul_u32_u24 v21, 136, v30
    s_add_u32 m0, s63, 16384
    s_nop 0
    buffer_load_dwordx4 v193, s[16:19], s75 offen sc1 lds
    v_mul_u32_u24 v22, 72, v30
    s_add_u32 s53, s53, 57344
    v_add3_u32 v21, v21, v23, s53
    v_add_u32 v22, v22, v23
    v_add_u32 v22, 74752, v22
    v_and_b32 v30, 15, v1
    v_lshl_add_u32 v30, v31, 4, v30
    v_bfe_u32 v23, v1, 4, 1
    v_lshl_add_u32 v30, v23, 5, v30
    s_add_u32 m0, s63, 20480
    s_nop 0
    buffer_load_dwordx4 v193, s[16:19], s76 offen sc1 lds
    v_lshlrev_b32 v251, 4, v30
    buffer_load_dword v196, v195, s[16:19], s92 offen sc1
    s_waitcnt vmcnt(7)
    s_barrier
    ds_read_b128 v[208:211], v14 offset:0
    s_add_u32 m0, s63, 24576
    s_nop 0
    buffer_load_dwordx4 v193, s[16:19], s77 offen sc1 lds
    ds_read_b128 v[212:215], v14 offset:896
    ds_read_b128 v[216:219], v14 offset:2048
    ds_read_b128 v[220:223], v14 offset:2944
    ds_read_b128 v[224:227], v14 offset:4096
    ds_read_b128 v[228:231], v14 offset:4992
    s_waitcnt lgkmcnt(5)
    v_mfma_f32_32x32x16_bf16 v[144:159], v[208:211], v[32:35], 0
    ds_read_b32 v160, v16 offset:0
    ds_read_b32 v161, v16 offset:2048
    ds_read_b32 v162, v16 offset:4096
    ds_read_b32 v163, v16 offset:6144
    s_waitcnt lgkmcnt(8)
    v_mfma_f32_32x32x16_bf16 v[144:159], v[212:215], v[36:39], v[144:159]
    ds_read_b32 v164, v16 offset:8192
    buffer_store_dwordx4 a[252:255], v3, s[16:19], s93 offen sc1
    ds_read_b128 v[208:211], v14 offset:6144
    s_waitcnt lgkmcnt(9)
    v_mfma_f32_32x32x16_bf16 v[144:159], v[216:219], v[40:43], v[144:159]
    ds_read_b32 v165, v16 offset:10240
    ds_read_b32 v166, v16 offset:12288
    ds_read_b128 v[212:215], v14 offset:7040
    s_waitcnt lgkmcnt(11)
    v_mfma_f32_32x32x16_bf16 v[144:159], v[220:223], v[44:47], v[144:159]
    buffer_store_dwordx4 a[252:255], v238, s[16:19], s94 offen sc1
    ds_read_b128 v[216:219], v14 offset:8192
    s_waitcnt lgkmcnt(11)
    v_mfma_f32_32x32x16_bf16 v[144:159], v[224:227], v[48:51], v[144:159]
    s_waitcnt lgkmcnt(2)
    v_add_f32 v160, v160, v161
    v_add_f32 v162, v162, v163
    v_add_f32 v164, v164, v165
    ds_read_b128 v[220:223], v14 offset:9088
    v_mfma_f32_32x32x16_bf16 v[144:159], v[228:231], v[52:55], v[144:159]
    v_add_f32 v160, v160, v166
    buffer_store_dwordx4 a[252:255], v239, s[16:19], s94 offen sc1
    ds_read_b128 v[224:227], v14 offset:10240
    v_mfma_f32_32x32x16_bf16 v[144:159], v[208:211], v[56:59], v[144:159]
    v_add_f32 v162, v162, v164
    v_add_f32 v160, v160, v162
    v_mov_b32 v161, v160
    s_nop 1
    v_permlane32_swap_b32 v160, v161
    ds_read_b128 v[228:231], v14 offset:11136
    s_waitcnt lgkmcnt(4)
    v_mfma_f32_32x32x16_bf16 v[144:159], v[212:215], v[60:63], v[144:159]
    v_add_f32 v160, v160, v161
    buffer_store_dwordx4 a[252:255], v197, s[16:19], s94 offen sc1
    ds_read_b128 v[208:211], v14 offset:12288
    s_waitcnt lgkmcnt(4)
    v_mfma_f32_32x32x16_bf16 v[144:159], v[216:219], v[64:67], v[144:159]
    ds_write_b32 v17, v160 offset:0
    ds_read_b128 v[212:215], v14 offset:13184
    s_waitcnt lgkmcnt(5)
    v_mfma_f32_32x32x16_bf16 v[144:159], v[220:223], v[68:71], v[144:159]
    s_waitcnt lgkmcnt(1)
    buffer_store_dwordx4 a[252:255], v4, s[16:19], s95 offen sc1
    ds_read_b128 v[216:219], v14 offset:14336
    v_mfma_f32_32x32x16_bf16 v[144:159], v[224:227], v[72:75], v[144:159]
    ds_read_b128 v[160:163], v18 offset:0
    ds_read_b128 v[164:167], v18 offset:32
    ds_read_b128 v[168:171], v18 offset:64
    ds_read_b128 v[220:223], v14 offset:15232
    v_mfma_f32_32x32x16_bf16 v[144:159], v[228:231], v[76:79], v[144:159]
    ds_read_b128 v[172:175], v18 offset:96
    buffer_store_dwordx4 a[252:255], v4, s[16:19], s95 offen offset:896 sc1
    ds_read_b128 v[224:227], v14 offset:16384
    v_mfma_f32_32x32x16_bf16 v[144:159], v[208:211], v[80:83], v[144:159]
    s_mov_b32 s26, 7340032
    s_mov_b32 s27, 0x20000
    s_mov_b32 s34, 3584
    s_mov_b32 s35, 0x20000
    s_mov_b32 s30, 7340032
    ds_read_b128 v[228:231], v14 offset:17280
    s_waitcnt lgkmcnt(8)
    v_mfma_f32_32x32x16_bf16 v[144:159], v[212:215], v[84:87], v[144:159]
    s_mov_b32 s31, 0x20000
    s_mov_b32 s38, 4096
    buffer_store_dwordx4 a[252:255], v4, s[16:19], s96 offen sc1
    ds_read_b128 v[208:211], v14 offset:18432
    s_waitcnt lgkmcnt(8)
    v_mfma_f32_32x32x16_bf16 v[144:159], v[216:219], v[88:91], v[144:159]
    s_mov_b32 s39, 0x20000
    s_mov_b32 s42, 1835008
    s_mov_b32 s43, 0x20000
    s_lshl_b32 s54, s50, 16
    s_add_u32 s54, s54, s63
    ds_read_b128 v[212:215], v14 offset:19328
    s_waitcnt lgkmcnt(5)
    v_mfma_f32_32x32x16_bf16 v[144:159], v[220:223], v[92:95], v[144:159]
    s_add_u32 s4, s54, 2883584
    s_add_u32 s89, s96, 100352
    buffer_store_dwordx4 a[252:255], v4, s[16:19], s89 offen sc1
    ds_read_b128 v[216:219], v14 offset:20480
    s_waitcnt lgkmcnt(4)
    v_mfma_f32_32x32x16_bf16 v[144:159], v[224:227], v[96:99], v[144:159]
    s_mul_i32 s53, s79, 28672
    s_mul_i32 s54, s48, 7168
    s_add_u32 s53, s53, s54
    s_add_u32 s5, s53, 3932160
    s_lshl_b32 s8, s79, 11
    ds_read_b128 v[220:223], v14 offset:21376
    s_waitcnt lgkmcnt(4)
    v_mfma_f32_32x32x16_bf16 v[144:159], v[228:231], v[100:103], v[144:159]
    s_add_u32 s8, s8, 524288
    s_lshl_b32 s53, s80, 9
    s_add_u32 s7, s53, s8
    v_lshrrev_b32 v31, 5, v1
    ds_read_b128 v[224:227], v14 offset:22528
    s_waitcnt lgkmcnt(4)
    v_mfma_f32_32x32x16_bf16 v[144:159], v[208:211], v[104:107], v[144:159]
    v_lshrrev_b32 v30, 3, v1
    v_bfe_u32 v25, v1, 4, 1
    v_lshlrev_b32 v27, 2, v25
    v_and_b32 v23, 7, v1
    ds_read_b128 v[228:231], v14 offset:23424
    s_waitcnt lgkmcnt(4)
    v_mfma_f32_32x32x16_bf16 v[144:159], v[212:215], v[108:111], v[144:159]
    v_xor_b32 v27, v27, v23
    v_lshlrev_b32 v27, 4, v27
    v_mul_u32_u24 v9, 3584, v30
    v_add_u32 v9, v9, v27
    ds_read_b128 v[208:211], v14 offset:24576
    s_waitcnt lgkmcnt(4)
    v_mfma_f32_32x32x16_bf16 v[144:159], v[216:219], v[112:115], v[144:159]
    v_add_u32 v10, 27648, v9
    v_lshl_add_u32 v11, v30, 12, v27
    v_add_u32 v12, 31744, v11
    v_bfe_u32 v30, v1, 2, 2
    ds_read_b128 v[212:215], v14 offset:25472
    s_waitcnt lgkmcnt(4)
    v_mfma_f32_32x32x16_bf16 v[144:159], v[220:223], v[116:119], v[144:159]
    v_lshl_add_u32 v27, v31, 2, v30
    v_lshlrev_b32 v27, 7, v27
    v_lshrrev_b32 v30, 1, v30
    v_lshlrev_b32 v30, 6, v30
    ds_read_b128 v[216:219], v14 offset:26624
    s_waitcnt lgkmcnt(4)
    v_mfma_f32_32x32x16_bf16 v[144:159], v[224:227], v[120:123], v[144:159]
    v_add_u32 v23, s48, v25
    v_and_b32 v23, 3, v23
    v_lshlrev_b32 v23, 5, v23
    v_xor_b32 v30, v23, v30
    ds_read_b128 v[220:223], v14 offset:27520
    s_waitcnt lgkmcnt(4)
    v_mfma_f32_32x32x16_bf16 v[144:159], v[228:231], v[124:127], v[144:159]
    v_and_b32 v23, 3, v1
    v_lshl_add_u32 v30, v23, 3, v30
    v_add3_u32 v232, v30, v27, s90
    v_xor_b32 v30, 64, v30
    s_waitcnt lgkmcnt(3)
    v_mfma_f32_32x32x16_bf16 v[144:159], v[208:211], v[128:131], v[144:159]
    v_add3_u32 v233, v30, v27, s90
    v_add_u32 v234, 0x10000, v232
    v_add_u32 v235, 0x10000, v233
    v_add_u32 v236, 0x20000, v232
    s_waitcnt lgkmcnt(2)
    v_mfma_f32_32x32x16_bf16 v[144:159], v[212:215], v[132:135], v[144:159]
    v_add_u32 v237, 0x20000, v233
    s_lshl2_add_u32 s53, s97, s48
    s_mul_i32 s54, s53, 917504
    s_lshl_b32 s55, s84, 7
    s_add_u32 s54, s54, s55
    s_add_u32 s55, s83, s84
    s_waitcnt lgkmcnt(1)
    v_mfma_f32_32x32x16_bf16 v[144:159], v[216:219], v[136:139], v[144:159]
    s_add_u32 s57, s55, 0
    s_and_b32 s57, s57, 3
    s_mul_i32 s68, s57, 3584
    s_lshl_b32 s64, s68, 6
    s_add_u32 s64, s64, s54
    s_add_u32 s57, s55, 1
    s_waitcnt lgkmcnt(0)
    v_mfma_f32_32x32x16_bf16 v[144:159], v[220:223], v[140:143], v[144:159]
    s_and_b32 s57, s57, 3
    s_mul_i32 s69, s57, 3584
    s_lshl_b32 s65, s69, 6
    s_add_u32 s65, s65, s54
    s_add_u32 s57, s55, 2
    s_and_b32 s57, s57, 3
    s_mul_i32 s70, s57, 3584
    s_lshl_b32 s66, s70, 6
    s_add_u32 s66, s66, s54
    s_add_u32 s57, s55, 3
    s_and_b32 s57, s57, 3
    s_mul_i32 s45, s57, 3584
    s_lshl_b32 s67, s45, 6
    s_add_u32 s67, s67, s54
    s_waitcnt vmcnt(8)
    v_cmp_ne_u32 vcc, s52, v196
    s_nop 0
    s_cbranch_vccnz re_5
bk_6:
    s_barrier
    ds_read_b128 v[208:211], v13 offset:0
    s_add_u32 m0, s63, 28672
    s_nop 0
    buffer_load_dwordx4 v7, s[16:19], s71 offen sc1 lds
    ds_read_b128 v[212:215], v13 offset:896
    ds_read_b128 v[216:219], v13 offset:2048
    ds_read_b128 v[220:223], v13 offset:2944
    ds_read_b128 v[224:227], v13 offset:4096
    ds_read_b128 v[228:231], v13 offset:4992
    s_waitcnt lgkmcnt(5)
    v_mfma_f32_32x32x16_bf16 v[176:191], v[208:211], v[32:35], 0
    ds_read_b32 v192, v15 offset:0
    ds_read_b32 v193, v15 offset:2048
    ds_read_b32 v194, v15 offset:4096
    ds_read_b32 v195, v15 offset:6144
    s_waitcnt lgkmcnt(8)
    v_mfma_f32_32x32x16_bf16 v[176:191], v[212:215], v[36:39], v[176:191]
    ds_read_b32 v196, v15 offset:8192
    ds_read_b32 v197, v15 offset:10240
    ds_read_b32 v198, v15 offset:12288
    ds_read_b128 v[208:211], v13 offset:6144
    s_waitcnt lgkmcnt(11)
    v_mfma_f32_32x32x16_bf16 v[176:191], v[216:219], v[40:43], v[176:191]
    s_add_u32 m0, s63, 32768
    s_nop 0
    buffer_load_dwordx4 v7, s[16:19], s72 offen sc1 lds
    ds_read_b128 v[212:215], v13 offset:7040
    s_waitcnt lgkmcnt(11)
    v_mfma_f32_32x32x16_bf16 v[176:191], v[220:223], v[44:47], v[176:191]
    s_waitcnt lgkmcnt(2)
    v_add_f32 v192, v192, v193
    v_add_f32 v194, v194, v195
    v_add_f32 v196, v196, v197
    ds_read_b128 v[216:219], v13 offset:8192
    v_mfma_f32_32x32x16_bf16 v[176:191], v[224:227], v[48:51], v[176:191]
    v_add_f32 v192, v192, v198
    v_add_f32 v194, v194, v196
    v_add_f32 v192, v192, v194
    v_mov_b32 v193, v192
    ds_read_b128 v[220:223], v13 offset:9088
    v_mfma_f32_32x32x16_bf16 v[176:191], v[228:231], v[52:55], v[176:191]
    s_add_u32 m0, s63, 36864
    s_nop 0
    buffer_load_dwordx4 v7, s[16:19], s73 offen sc1 lds
    ds_read_b128 v[224:227], v13 offset:10240
    s_waitcnt lgkmcnt(4)
    v_mfma_f32_32x32x16_bf16 v[176:191], v[208:211], v[56:59], v[176:191]
    v_permlane32_swap_b32 v192, v193
    v_add_f32 v192, v192, v193
    ds_write_b32 v17, v192 offset:128
    ds_read_b128 v[228:231], v13 offset:11136
    s_waitcnt lgkmcnt(5)
    v_mfma_f32_32x32x16_bf16 v[176:191], v[212:215], v[60:63], v[176:191]
    s_waitcnt lgkmcnt(1)
    ds_read_b128 v[192:195], v18 offset:128
    ds_read_b128 v[196:199], v18 offset:160
    ds_read_b128 v[208:211], v13 offset:12288
    v_mfma_f32_32x32x16_bf16 v[176:191], v[216:219], v[64:67], v[176:191]
    s_add_u32 m0, s63, 40960
    s_nop 0
    buffer_load_dwordx4 v7, s[16:19], s74 offen sc1 lds
    ds_read_b128 v[212:215], v13 offset:13184
    v_mfma_f32_32x32x16_bf16 v[176:191], v[220:223], v[68:71], v[176:191]
    ds_read_b128 v[200:203], v18 offset:192
    ds_read_b128 v[204:207], v18 offset:224
    ds_read_b128 v[216:219], v13 offset:14336
    v_mfma_f32_32x32x16_bf16 v[176:191], v[224:227], v[72:75], v[176:191]
    v_fmac_f32 v144, v160, v24
    v_fmac_f32 v145, v161, v24
    v_fmac_f32 v146, v162, v24
    v_fmac_f32 v147, v163, v24
    ds_read_b128 v[220:223], v13 offset:15232
    s_waitcnt lgkmcnt(8)
    v_mfma_f32_32x32x16_bf16 v[176:191], v[228:231], v[76:79], v[176:191]
    s_add_u32 m0, s63, 45056
    s_nop 0
    buffer_load_dwordx4 v7, s[16:19], s75 offen sc1 lds
    ds_read_b128 v[224:227], v13 offset:16384
    s_waitcnt lgkmcnt(6)
    v_mfma_f32_32x32x16_bf16 v[176:191], v[208:211], v[80:83], v[176:191]
    v_fmac_f32 v148, v164, v24
    v_fmac_f32 v149, v165, v24
    v_fmac_f32 v150, v166, v24
    v_fmac_f32 v151, v167, v24
    ds_read_b128 v[228:231], v13 offset:17280
    s_waitcnt lgkmcnt(6)
    v_mfma_f32_32x32x16_bf16 v[176:191], v[212:215], v[84:87], v[176:191]
    v_fmac_f32 v152, v168, v24
    v_fmac_f32 v153, v169, v24
    v_fmac_f32 v154, v170, v24
    v_fmac_f32 v155, v171, v24
    ds_read_b128 v[208:211], v13 offset:18432
    s_waitcnt lgkmcnt(4)
    v_mfma_f32_32x32x16_bf16 v[176:191], v[216:219], v[88:91], v[176:191]
    s_add_u32 m0, s63, 49152
    s_nop 0
    buffer_load_dwordx4 v7, s[16:19], s76 offen sc1 lds
    ds_read_b128 v[212:215], v13 offset:19328
    s_waitcnt lgkmcnt(4)
    v_mfma_f32_32x32x16_bf16 v[176:191], v[220:223], v[92:95], v[176:191]
    v_fmac_f32 v156, v172, v24
    v_fmac_f32 v157, v173, v24
    v_fmac_f32 v158, v174, v24
    v_fmac_f32 v159, v175, v24
    ds_read_b128 v[216:219], v13 offset:20480
    s_waitcnt lgkmcnt(4)
    v_mfma_f32_32x32x16_bf16 v[176:191], v[224:227], v[96:99], v[176:191]
    v_max_f32 v30, v144, v145
    v_min_f32 v31, v144, v145
    v_max3_f32 v30, v30, v146, v147
    v_min3_f32 v31, v31, v146, v147
    ds_read_b128 v[220:223], v13 offset:21376
    s_waitcnt lgkmcnt(4)
    v_mfma_f32_32x32x16_bf16 v[176:191], v[228:231], v[100:103], v[176:191]
    s_add_u32 m0, s63, 53248
    s_nop 0
    buffer_load_dwordx4 v7, s[16:19], s77 offen sc1 lds
    ds_read_b128 v[224:227], v13 offset:22528
    s_waitcnt lgkmcnt(4)
    v_mfma_f32_32x32x16_bf16 v[176:191], v[208:211], v[104:107], v[176:191]
    v_max3_f32 v30, v30, v148, v149
    v_min3_f32 v31, v31, v148, v149
    v_max3_f32 v30, v30, v150, v151
    ds_read_b128 v[228:231], v13 offset:23424
    s_waitcnt lgkmcnt(4)
    v_mfma_f32_32x32x16_bf16 v[176:191], v[212:215], v[108:111], v[176:191]
    v_min3_f32 v31, v31, v150, v151
    v_max3_f32 v30, v30, v152, v153
    v_min3_f32 v31, v31, v152, v153
    ds_read_b128 v[208:211], v13 offset:24576
    s_waitcnt lgkmcnt(4)
    v_mfma_f32_32x32x16_bf16 v[176:191], v[216:219], v[112:115], v[176:191]
    s_add_u32 m0, s90, 90112
    s_nop 0
    buffer_load_dwordx4 v9, s[24:27], s64 offen lds
    buffer_load_dwordx4 v10, s[24:27], s64 offen offset:1024 lds
    ds_read_b128 v[212:215], v13 offset:25472
    s_waitcnt lgkmcnt(4)
    v_mfma_f32_32x32x16_bf16 v[176:191], v[220:223], v[116:119], v[176:191]
    v_max3_f32 v30, v30, v154, v155
    v_min3_f32 v31, v31, v154, v155
    v_max3_f32 v30, v30, v156, v157
    ds_read_b128 v[216:219], v13 offset:26624
    s_waitcnt lgkmcnt(4)
    v_mfma_f32_32x32x16_bf16 v[176:191], v[224:227], v[120:123], v[176:191]
    v_min3_f32 v31, v31, v156, v157
    v_max3_f32 v30, v30, v158, v159
    v_min3_f32 v31, v31, v158, v159
    ds_read_b128 v[220:223], v13 offset:27520
    s_waitcnt lgkmcnt(4)
    v_mfma_f32_32x32x16_bf16 v[176:191], v[228:231], v[124:127], v[176:191]
    v_mov_b32 v23, v30
    v_mov_b32 v25, v31
    s_nop 0
    v_permlane32_swap_b32 v30, v23
    v_permlane32_swap_b32 v31, v25
    v_max_f32 v30, v30, v23
    s_waitcnt lgkmcnt(3)
    v_mfma_f32_32x32x16_bf16 v[176:191], v[208:211], v[128:131], v[176:191]
    v_min_f32 v31, v31, v25
    v_mul_f32 v252, v30, v26
    v_mul_f32 v254, v31, v26
    v_mov_b32 v23, 0x7f800000
    v_cndmask_b32 v30, v252, v23, s[60:61]
    s_waitcnt lgkmcnt(2)
    v_mfma_f32_32x32x16_bf16 v[176:191], v[212:215], v[132:135], v[176:191]
    v_cndmask_b32 v6, v254, -v23, s[60:61]
    v_fma_f32 v160, -v144, v26, v254
    v_fma_f32 v144, v144, v26, -v252
    v_fma_f32 v161, -v145, v26, v254
    s_waitcnt lgkmcnt(1)
    v_mfma_f32_32x32x16_bf16 v[176:191], v[216:219], v[136:139], v[176:191]
    s_add_u32 m0, s90, 98304
    s_add_u32 s88, s64, 57344
    buffer_load_dwordx4 v9, s[24:27], s88 offen lds
    buffer_load_dwordx4 v10, s[24:27], s88 offen offset:1024 lds
    s_waitcnt lgkmcnt(0)
    v_mfma_f32_32x32x16_bf16 v[176:191], v[220:223], v[140:143], v[176:191]
    s_waitcnt vmcnt(11)
    s_barrier
    buffer_store_dword v250, v0, s[16:19], s56 offen sc1
    v_fma_f32 v145, v145, v26, -v252
    s_add_u32 m0, s90, 106496
    s_add_u32 s88, s64, 114688
    buffer_load_dwordx4 v9, s[24:27], s88 offen lds
    buffer_load_dwordx4 v10, s[24:27], s88 offen offset:1024 lds
    v_fma_f32 v162, -v146, v26, v254
    v_fma_f32 v146, v146, v26, -v252
    v_fma_f32 v163, -v147, v26, v254
    v_fma_f32 v147, v147, v26, -v252
    v_fma_f32 v164, -v148, v26, v254
    v_fma_f32 v148, v148, v26, -v252
    v_fma_f32 v165, -v149, v26, v254
    v_fma_f32 v149, v149, v26, -v252
    v_fma_f32 v166, -v150, v26, v254
    v_fma_f32 v150, v150, v26, -v252
    v_fma_f32 v167, -v151, v26, v254
    v_fma_f32 v151, v151, v26, -v252
    v_fma_f32 v168, -v152, v26, v254
    v_fma_f32 v152, v152, v26, -v252
    v_fma_f32 v169, -v153, v26, v254
    v_fma_f32 v153, v153, v26, -v252
    v_fma_f32 v170, -v154, v26, v254
    s_add_u32 m0, s90, 155648
    s_add_u32 s88, s64, 172032
    buffer_load_dwordx4 v9, s[24:27], s88 offen lds
    buffer_load_dwordx4 v10, s[24:27], s88 offen offset:1024 lds
    v_fma_f32 v154, v154, v26, -v252
    v_fma_f32 v171, -v155, v26, v254
    v_fma_f32 v155, v155, v26, -v252
    v_fma_f32 v172, -v156, v26, v6
    v_fma_f32 v156, v156, v26, -v30
    v_fma_f32 v173, -v157, v26, v6
    v_fma_f32 v157, v157, v26, -v30
    v_fma_f32 v174, -v158, v26, v6
    v_fma_f32 v158, v158, v26, -v30
    v_fma_f32 v175, -v159, v26, v6
    v_fma_f32 v159, v159, v26, -v30
    v_exp_f32 v144, v144
    v_exp_f32 v160, v160
    v_exp_f32 v145, v145
    v_exp_f32 v161, v161
    v_exp_f32 v146, v146
    v_exp_f32 v162, v162
    v_exp_f32 v147, v147
    v_exp_f32 v163, v163
    v_exp_f32 v148, v148
    v_exp_f32 v164, v164
    v_exp_f32 v149, v149
    v_exp_f32 v165, v165
    v_exp_f32 v150, v150
    v_exp_f32 v166, v166
    v_exp_f32 v151, v151
    v_exp_f32 v167, v167
    v_exp_f32 v152, v152
    v_exp_f32 v168, v168
    v_exp_f32 v153, v153
    v_exp_f32 v169, v169
    v_exp_f32 v154, v154
    v_exp_f32 v170, v170
    v_exp_f32 v155, v155
    v_exp_f32 v171, v171
    v_exp_f32 v156, v156
    v_exp_f32 v172, v172
    v_exp_f32 v157, v157
    v_exp_f32 v173, v173
    v_exp_f32 v158, v158
    v_exp_f32 v174, v174
    v_exp_f32 v159, v159
    v_exp_f32 v175, v175
    v_pk_add_f32 v[252:253], v[144:145], v[146:147]
    v_pk_add_f32 v[254:255], v[160:161], v[162:163]
    v_pk_add_f32 v[252:253], v[252:253], v[148:149]
    v_pk_add_f32 v[254:255], v[254:255], v[164:165]
    v_pk_add_f32 v[252:253], v[252:253], v[150:151]
    v_pk_add_f32 v[254:255], v[254:255], v[166:167]
    v_pk_add_f32 v[252:253], v[252:253], v[152:153]
    v_pk_add_f32 v[254:255], v[254:255], v[168:169]
    v_pk_add_f32 v[252:253], v[252:253], v[154:155]
    v_pk_add_f32 v[254:255], v[254:255], v[170:171]
    v_pk_add_f32 v[252:253], v[252:253], v[156:157]
    v_pk_add_f32 v[254:255], v[254:255], v[172:173]
    v_pk_add_f32 v[252:253], v[252:253], v[158:159]
    v_pk_add_f32 v[254:255], v[254:255], v[174:175]
    v_add_f32 v252, v252, v253
    v_add_f32 v254, v254, v255
    v_mov_b32 v23, v252
    v_mov_b32 v25, v254
    s_nop 0
    v_permlane32_swap_b32 v252, v23
    v_permlane32_swap_b32 v254, v25
    v_add_f32 v252, v252, v23
    v_add_f32 v254, v254, v25
    v_rcp_f32 v252, v252
    v_rcp_f32 v254, v254
    v_pk_mul_f32 v[144:145], v[144:145], v[252:253] op_sel_hi:[1,0]
    v_pk_mul_f32 v[160:161], v[160:161], v[254:255] op_sel_hi:[1,0]
    v_pk_mul_f32 v[146:147], v[146:147], v[252:253] op_sel_hi:[1,0]
    v_pk_mul_f32 v[162:163], v[162:163], v[254:255] op_sel_hi:[1,0]
    v_pk_mul_f32 v[148:149], v[148:149], v[252:253] op_sel_hi:[1,0]
    v_pk_mul_f32 v[164:165], v[164:165], v[254:255] op_sel_hi:[1,0]
    v_pk_mul_f32 v[150:151], v[150:151], v[252:253] op_sel_hi:[1,0]
    v_pk_mul_f32 v[166:167], v[166:167], v[254:255] op_sel_hi:[1,0]
    v_pk_mul_f32 v[152:153], v[152:153], v[252:253] op_sel_hi:[1,0]
    v_pk_mul_f32 v[168:169], v[168:169], v[254:255] op_sel_hi:[1,0]
    v_pk_mul_f32 v[154:155], v[154:155], v[252:253] op_sel_hi:[1,0]
    v_pk_mul_f32 v[170:171], v[170:171], v[254:255] op_sel_hi:[1,0]
    v_pk_mul_f32 v[156:157], v[156:157], v[252:253] op_sel_hi:[1,0]
    v_pk_mul_f32 v[172:173], v[172:173], v[254:255] op_sel_hi:[1,0]
    v_pk_mul_f32 v[158:159], v[158:159], v[252:253] op_sel_hi:[1,0]
    v_pk_mul_f32 v[174:175], v[174:175], v[254:255] op_sel_hi:[1,0]
    v_cvt_pk_bf16_f32 v144, v144, v145
    v_cvt_pk_bf16_f32 v145, v146, v147
    v_cvt_pk_bf16_f32 v146, v148, v149
    v_cvt_pk_bf16_f32 v147, v150, v151
    v_cvt_pk_bf16_f32 v148, v152, v153
    v_cvt_pk_bf16_f32 v149, v154, v155
    v_cvt_pk_bf16_f32 v150, v156, v157
    v_cvt_pk_bf16_f32 v151, v158, v159
    v_cvt_pk_bf16_f32 v160, v160, v161
    v_cvt_pk_bf16_f32 v161, v162, v163
    v_cvt_pk_bf16_f32 v162, v164, v165
    v_cvt_pk_bf16_f32 v163, v166, v167
    v_cvt_pk_bf16_f32 v164, v168, v169
    v_cvt_pk_bf16_f32 v165, v170, v171
    v_cvt_pk_bf16_f32 v166, v172, v173
    v_cvt_pk_bf16_f32 v167, v174, v175
    ds_write_b64 v19, v[144:145] offset:0
    ds_write_b64 v19, v[146:147] offset:16
    ds_write_b64 v19, v[148:149] offset:32
    ds_write_b64 v19, v[150:151] offset:48
    ds_write_b64 v19, v[160:161] offset:64
    ds_write_b64 v19, v[162:163] offset:80
    ds_write_b64 v19, v[164:165] offset:96
    ds_write_b64 v19, v[166:167] offset:112
    v_pk_fma_f32 v[176:177], v[192:193], v[24:25], v[176:177] op_sel_hi:[1,0,1]
    v_pk_fma_f32 v[178:179], v[194:195], v[24:25], v[178:179] op_sel_hi:[1,0,1]
    v_pk_fma_f32 v[180:181], v[196:197], v[24:25], v[180:181] op_sel_hi:[1,0,1]
    v_pk_fma_f32 v[182:183], v[198:199], v[24:25], v[182:183] op_sel_hi:[1,0,1]
    v_pk_fma_f32 v[184:185], v[200:201], v[24:25], v[184:185] op_sel_hi:[1,0,1]
    v_pk_fma_f32 v[186:187], v[202:203], v[24:25], v[186:187] op_sel_hi:[1,0,1]
    v_pk_fma_f32 v[188:189], v[204:205], v[24:25], v[188:189] op_sel_hi:[1,0,1]
    v_pk_fma_f32 v[190:191], v[206:207], v[24:25], v[190:191] op_sel_hi:[1,0,1]
    v_pk_mul_f32 v[176:177], v[176:177], v[28:29] op_sel_hi:[1,0]
    v_pk_mul_f32 v[178:179], v[178:179], v[28:29] op_sel_hi:[1,0]
    v_pk_mul_f32 v[180:181], v[180:181], v[28:29] op_sel_hi:[1,0]
    v_pk_mul_f32 v[182:183], v[182:183], v[28:29] op_sel_hi:[1,0]
    v_pk_mul_f32 v[184:185], v[184:185], v[28:29] op_sel_hi:[1,0]
    v_pk_mul_f32 v[186:187], v[186:187], v[28:29] op_sel_hi:[1,0]
    v_pk_mul_f32 v[188:189], v[188:189], v[28:29] op_sel_hi:[1,0]
    v_pk_mul_f32 v[190:191], v[190:191], v[28:29] op_sel_hi:[1,0]
    v_cvt_pk_bf16_f32 v192, v176, v177
    v_cvt_pk_bf16_f32 v193, v178, v179
    v_cvt_pk_bf16_f32 v194, v180, v181
    v_cvt_pk_bf16_f32 v195, v182, v183
    v_cvt_pk_bf16_f32 v196, v184, v185
    v_cvt_pk_bf16_f32 v197, v186, v187
    v_cvt_pk_bf16_f32 v198, v188, v189
    v_cvt_pk_bf16_f32 v199, v190, v191
    v_mov_b32 v23, 0x3f80
    v_cndmask_b32 v198, v198, v23, s[60:61]
    v_cndmask_b32 v199, v199, 0, s[60:61]
    ds_write_b64 v20, v[192:193] offset:0
    ds_write_b64 v20, v[194:195] offset:16
    ds_write_b64 v20, v[196:197] offset:32
    ds_write_b64 v20, v[198:199] offset:48
    s_waitcnt vmcnt(9)
    s_waitcnt lgkmcnt(0)
    s_barrier
    ds_read_b64_tr_b16 v[144:145], v21 offset:0
    ds_read_b64_tr_b16 v[146:147], v21 offset:544
    ds_read_b64_tr_b16 v[160:161], v22 offset:0
    ds_read_b64_tr_b16 v[162:163], v22 offset:288
    ds_read_b64_tr_b16 v[164:165], v22 offset:32
    ds_read_b64_tr_b16 v[166:167], v22 offset:320
    ds_read_b64_tr_b16 v[148:149], v21 offset:4352
    ds_read_b64_tr_b16 v[150:151], v21 offset:4896
    ds_read_b64_tr_b16 v[168:169], v22 offset:2304
    ds_read_b64_tr_b16 v[170:171], v22 offset:2592
    ds_read_b64_tr_b16 v[172:173], v22 offset:2336
    ds_read_b64_tr_b16 v[174:175], v22 offset:2624
    ds_read_b64_tr_b16 v[152:153], v21 offset:8704
    ds_read_b64_tr_b16 v[154:155], v21 offset:9248
    ds_read_b64_tr_b16 v[176:177], v22 offset:4608
    ds_read_b64_tr_b16 v[178:179], v22 offset:4896
    ds_read_b64_tr_b16 v[180:181], v22 offset:4640
    ds_read_b64_tr_b16 v[182:183], v22 offset:4928
    ds_read_b64_tr_b16 v[156:157], v21 offset:13056
    ds_read_b64_tr_b16 v[158:159], v21 offset:13600
    ds_read_b64_tr_b16 v[184:185], v22 offset:6912
    ds_read_b64_tr_b16 v[186:187], v22 offset:7200
    ds_read_b64_tr_b16 v[188:189], v22 offset:6944
    ds_read_b64_tr_b16 v[190:191], v22 offset:7232
    s_waitcnt lgkmcnt(15)
    v_mfma_f32_16x16x32_bf16 v[192:195], v[144:147], v[160:163], 0
    v_mfma_f32_16x16x32_bf16 v[196:199], v[144:147], v[164:167], 0
    s_waitcnt lgkmcnt(12)
    v_mfma_f32_16x16x32_bf16 v[192:195], v[148:151], v[168:171], v[192:195]
    v_mfma_f32_16x16x32_bf16 v[196:199], v[148:151], v[172:175], v[196:199]
    s_waitcnt lgkmcnt(6)
    v_mfma_f32_16x16x32_bf16 v[192:195], v[152:155], v[176:179], v[192:195]
    v_mfma_f32_16x16x32_bf16 v[196:199], v[152:155], v[180:183], v[196:199]
    s_waitcnt lgkmcnt(0)
    v_mfma_f32_16x16x32_bf16 v[192:195], v[156:159], v[184:187], v[192:195]
    v_mfma_f32_16x16x32_bf16 v[196:199], v[156:159], v[188:191], v[196:199]
    ds_read_b128 v[208:211], v13 offset:28672
    ds_read_b128 v[212:215], v13 offset:29568
    ds_read_b128 v[216:219], v13 offset:30720
    ds_read_b128 v[220:223], v13 offset:31616
    ds_read_b128 v[224:227], v13 offset:32768
    ds_read_b128 v[228:231], v13 offset:33664
    s_nop 0
    v_cvt_pk_bf16_f32 v200, v192, v193
    v_cvt_pk_bf16_f32 v201, v194, v195
    v_cvt_pk_bf16_f32 v202, v196, v197
    v_cvt_pk_bf16_f32 v203, v198, v199
    s_nop 0
    v_permlane32_swap_b32 v200, v202
    v_permlane32_swap_b32 v201, v203
    buffer_store_dwordx4 v[200:203], v251, s[16:19], s93 offen sc1
    s_waitcnt lgkmcnt(5)
    v_mfma_f32_32x32x16_bf16 v[144:159], v[208:211], v[32:35], 0
    ds_read_b32 v160, v15 offset:28672
    ds_read_b32 v161, v15 offset:30720
    buffer_load_dwordx4 a[0:3], v4, s[16:19], s100 offen offset:0 sc1
    s_waitcnt lgkmcnt(6)
    v_mfma_f32_32x32x16_bf16 v[144:159], v[212:215], v[36:39], v[144:159]
    ds_read_b32 v162, v15 offset:32768
    buffer_load_dwordx4 a[4:7], v4, s[16:19], s100 offen offset:896 sc1
    ds_read_b128 v[208:211], v13 offset:34816
    s_waitcnt lgkmcnt(7)
    v_mfma_f32_32x32x16_bf16 v[144:159], v[216:219], v[40:43], v[144:159]
    ds_read_b32 v163, v15 offset:34816
    buffer_load_dwordx4 a[8:11], v4, s[16:19], s100 offen offset:2048 sc1
    ds_read_b128 v[212:215], v13 offset:35712
    s_waitcnt lgkmcnt(8)
    v_mfma_f32_32x32x16_bf16 v[144:159], v[220:223], v[44:47], v[144:159]
    ds_read_b32 v164, v15 offset:36864
    buffer_load_dwordx4 a[12:15], v4, s[16:19], s100 offen offset:2944 sc1
    ds_read_b128 v[216:219], v13 offset:36864
    s_waitcnt lgkmcnt(9)
    v_mfma_f32_32x32x16_bf16 v[144:159], v[224:227], v[48:51], v[144:159]
    s_add_u32 s100, s100, 4096
    buffer_load_dwordx4 a[16:19], v4, s[16:19], s100 offen offset:0 sc1
    ds_read_b128 v[220:223], v13 offset:37760
    s_waitcnt lgkmcnt(9)
    v_mfma_f32_32x32x16_bf16 v[144:159], v[228:231], v[52:55], v[144:159]
    ds_read_b32 v165, v15 offset:38912
    ds_read_b32 v166, v15 offset:40960
    ds_read_b128 v[224:227], v13 offset:38912
    s_waitcnt lgkmcnt(8)
    v_mfma_f32_32x32x16_bf16 v[144:159], v[208:211], v[56:59], v[144:159]
    buffer_load_dwordx4 a[20:23], v4, s[16:19], s100 offen offset:896 sc1
    ds_read_b128 v[228:231], v13 offset:39808
    s_waitcnt lgkmcnt(7)
    v_mfma_f32_32x32x16_bf16 v[144:159], v[212:215], v[60:63], v[144:159]
    s_waitcnt lgkmcnt(2)
    v_add_f32 v160, v160, v161
    v_add_f32 v162, v162, v163
    v_add_f32 v164, v164, v165
    ds_read_b128 v[208:211], v13 offset:40960
    v_mfma_f32_32x32x16_bf16 v[144:159], v[216:219], v[64:67], v[144:159]
    v_add_f32 v160, v160, v166
    buffer_load_dwordx4 a[24:27], v4, s[16:19], s100 offen offset:2048 sc1
    ds_read_b128 v[212:215], v13 offset:41856
    v_mfma_f32_32x32x16_bf16 v[144:159], v[220:223], v[68:71], v[144:159]
    v_add_f32 v162, v162, v164
    v_add_f32 v160, v160, v162
    v_mov_b32 v161, v160
    s_nop 1
    v_permlane32_swap_b32 v160, v161
    ds_read_b128 v[216:219], v13 offset:43008
    s_waitcnt lgkmcnt(4)
    v_mfma_f32_32x32x16_bf16 v[144:159], v[224:227], v[72:75], v[144:159]
    v_add_f32 v160, v160, v161
    buffer_load_dwordx4 a[28:31], v4, s[16:19], s100 offen offset:2944 sc1
    ds_read_b128 v[220:223], v13 offset:43904
    s_waitcnt lgkmcnt(4)
    v_mfma_f32_32x32x16_bf16 v[144:159], v[228:231], v[76:79], v[144:159]
    ds_write_b32 v17, v160 offset:256
    ds_read_b128 v[224:227], v13 offset:45056
    s_waitcnt lgkmcnt(5)
    v_mfma_f32_32x32x16_bf16 v[144:159], v[208:211], v[80:83], v[144:159]
    s_waitcnt lgkmcnt(1)
    s_add_u32 s100, s100, 4096
    buffer_load_dwordx4 a[32:35], v4, s[16:19], s100 offen offset:0 sc1
    ds_read_b128 v[228:231], v13 offset:45952
    v_mfma_f32_32x32x16_bf16 v[144:159], v[212:215], v[84:87], v[144:159]
    ds_read_b128 v[160:163], v18 offset:256
    ds_read_b128 v[164:167], v18 offset:288
    ds_read_b128 v[168:171], v18 offset:320
    ds_read_b128 v[208:211], v13 offset:47104
    v_mfma_f32_32x32x16_bf16 v[144:159], v[216:219], v[88:91], v[144:159]
    buffer_load_dwordx4 a[36:39], v4, s[16:19], s100 offen offset:896 sc1
    s_mov_b32 s101, 131072
    buffer_load_dword v176, v5, s[16:19], s101 offen sc1
    ds_read_b128 v[212:215], v13 offset:48000
    v_mfma_f32_32x32x16_bf16 v[144:159], v[220:223], v[92:95], v[144:159]
    ds_read_b128 v[172:175], v18 offset:352
    v_lshrrev_b32 v23, 4, v1
    v_and_b32 v30, 15, v1
    ds_read_b128 v[216:219], v13 offset:49152
    s_waitcnt lgkmcnt(8)
    v_mfma_f32_32x32x16_bf16 v[144:159], v[224:227], v[96:99], v[144:159]
    v_and_b32 v25, 1, v23
    buffer_load_dwordx4 a[40:43], v4, s[16:19], s100 offen offset:2048 sc1
    ds_read_b128 v[220:223], v13 offset:50048
    s_waitcnt lgkmcnt(8)
    v_mfma_f32_32x32x16_bf16 v[144:159], v[228:231], v[100:103], v[144:159]
    v_lshrrev_b32 v23, 1, v23
    v_lshlrev_b32 v251, 4, v30
    v_lshl_add_u32 v184, v23, 9, v251
    v_lshl_add_u32 v184, v25, 3, v184
    ds_read_b128 v[224:227], v13 offset:51200
    s_waitcnt lgkmcnt(5)
    v_mfma_f32_32x32x16_bf16 v[144:159], v[208:211], v[104:107], v[144:159]
    v_lshl_add_u32 v251, v25, 9, v251
    buffer_load_dwordx4 a[44:47], v4, s[16:19], s100 offen offset:2944 sc1
    ds_read_b128 v[228:231], v13 offset:52096
    s_waitcnt lgkmcnt(5)
    v_mfma_f32_32x32x16_bf16 v[144:159], v[212:215], v[108:111], v[144:159]
    v_lshl_add_u32 v251, v23, 12, v251
    v_add_u32 v251, s4, v251
    v_lshlrev_b32 v25, 3, v25
    v_sub_u32 v30, v30, v25
    ds_read_b128 v[208:211], v13 offset:53248
    s_waitcnt lgkmcnt(4)
    v_mfma_f32_32x32x16_bf16 v[144:159], v[216:219], v[112:115], v[144:159]
    s_add_u32 s100, s100, 4096
    buffer_load_dwordx4 a[48:51], v4, s[16:19], s100 offen offset:0 sc1
    ds_read_b128 v[212:215], v13 offset:54144
    s_waitcnt lgkmcnt(4)
    v_mfma_f32_32x32x16_bf16 v[144:159], v[220:223], v[116:119], v[144:159]
    v_and_b32 v23, 1, v30
    v_lshlrev_b32 v23, 4, v23
    v_mov_b32 v25, 0x3f80
    ds_read_b128 v[216:219], v13 offset:55296
    s_waitcnt lgkmcnt(4)
    v_mfma_f32_32x32x16_bf16 v[144:159], v[224:227], v[120:123], v[144:159]
    v_lshlrev_b32 v23, v23, v25
    buffer_load_dwordx4 a[52:55], v4, s[16:19], s100 offen offset:896 sc1
    ds_read_b128 v[220:223], v13 offset:56192
    s_waitcnt lgkmcnt(4)
    v_mfma_f32_32x32x16_bf16 v[144:159], v[228:231], v[124:127], v[144:159]
    v_ashrrev_i32 v30, 1, v30
    s_add_u32 s53, s63, 86016
    v_add_u32 v184, s53, v184
    v_add_u32 v185, 86016, v3
    s_waitcnt lgkmcnt(3)
    v_mfma_f32_32x32x16_bf16 v[144:159], v[208:211], v[128:131], v[144:159]
    v_cmp_eq_u32 vcc, 0, v30
    s_nop 1
    v_cndmask_b32 v180, 0, v23, vcc
    buffer_load_dwordx4 a[56:59], v4, s[16:19], s100 offen offset:2048 sc1
    s_waitcnt lgkmcnt(2)
    v_mfma_f32_32x32x16_bf16 v[144:159], v[212:215], v[132:135], v[144:159]
    v_cmp_eq_u32 vcc, 1, v30
    s_nop 1
    v_cndmask_b32 v181, 0, v23, vcc
    v_cmp_eq_u32 vcc, 2, v30
    s_nop 1
    v_cndmask_b32 v182, 0, v23, vcc
    s_waitcnt lgkmcnt(1)
    v_mfma_f32_32x32x16_bf16 v[144:159], v[216:219], v[136:139], v[144:159]
    v_cmp_eq_u32 vcc, 3, v30
    s_nop 1
    v_cndmask_b32 v183, 0, v23, vcc
    buffer_load_dwordx4 a[60:63], v4, s[16:19], s100 offen offset:2944 sc1
    s_waitcnt lgkmcnt(0)
    v_mfma_f32_32x32x16_bf16 v[144:159], v[220:223], v[140:143], v[144:159]
    s_nop 11
    v_pk_fma_f32 v[144:145], v[160:161], v[24:25], v[144:145] op_sel_hi:[1,0,1]
    v_pk_fma_f32 v[146:147], v[162:163], v[24:25], v[146:147] op_sel_hi:[1,0,1]
    v_pk_fma_f32 v[148:149], v[164:165], v[24:25], v[148:149] op_sel_hi:[1,0,1]
    v_pk_fma_f32 v[150:151], v[166:167], v[24:25], v[150:151] op_sel_hi:[1,0,1]
    v_pk_fma_f32 v[152:153], v[168:169], v[24:25], v[152:153] op_sel_hi:[1,0,1]
    v_pk_fma_f32 v[154:155], v[170:171], v[24:25], v[154:155] op_sel_hi:[1,0,1]
    v_pk_fma_f32 v[156:157], v[172:173], v[24:25], v[156:157] op_sel_hi:[1,0,1]
    v_pk_fma_f32 v[158:159], v[174:175], v[24:25], v[158:159] op_sel_hi:[1,0,1]
    v_max_f32 v30, v144, v145
    v_min_f32 v31, v144, v145
    v_max3_f32 v30, v30, v146, v147
    v_min3_f32 v31, v31, v146, v147
    v_max3_f32 v30, v30, v148, v149
    v_min3_f32 v31, v31, v148, v149
    v_max3_f32 v30, v30, v150, v151
    v_min3_f32 v31, v31, v150, v151
    v_max3_f32 v30, v30, v152, v153
    v_min3_f32 v31, v31, v152, v153
    v_max3_f32 v30, v30, v154, v155
    v_min3_f32 v31, v31, v154, v155
    v_max3_f32 v30, v30, v156, v157
    v_min3_f32 v31, v31, v156, v157
    v_max3_f32 v30, v30, v158, v159
    v_min3_f32 v31, v31, v158, v159
    v_mov_b32 v23, v30
    v_mov_b32 v25, v31
    s_nop 0
    v_permlane32_swap_b32 v30, v23
    v_permlane32_swap_b32 v31, v25
    v_max_f32 v30, v30, v23
    v_min_f32 v31, v31, v25
    v_mul_f32 v252, v30, v26
    v_mul_f32 v254, v31, v26
    v_mov_b32 v23, 0x7f800000
    v_cndmask_b32 v30, v252, v23, s[60:61]
    v_cndmask_b32 v6, v254, -v23, s[60:61]
    v_pk_fma_f32 v[160:161], v[144:145], v[26:27], v[254:255] op_sel_hi:[1,0,0] neg_lo:[1,0,0] neg_hi:[1,0,0]
    v_pk_fma_f32 v[144:145], v[144:145], v[26:27], v[252:253] op_sel_hi:[1,0,0] neg_lo:[0,0,1] neg_hi:[0,0,1]
    v_pk_fma_f32 v[162:163], v[146:147], v[26:27], v[254:255] op_sel_hi:[1,0,0] neg_lo:[1,0,0] neg_hi:[1,0,0]
    v_pk_fma_f32 v[146:147], v[146:147], v[26:27], v[252:253] op_sel_hi:[1,0,0] neg_lo:[0,0,1] neg_hi:[0,0,1]
    v_pk_fma_f32 v[164:165], v[148:149], v[26:27], v[254:255] op_sel_hi:[1,0,0] neg_lo:[1,0,0] neg_hi:[1,0,0]
    v_pk_fma_f32 v[148:149], v[148:149], v[26:27], v[252:253] op_sel_hi:[1,0,0] neg_lo:[0,0,1] neg_hi:[0,0,1]
    v_pk_fma_f32 v[166:167], v[150:151], v[26:27], v[254:255] op_sel_hi:[1,0,0] neg_lo:[1,0,0] neg_hi:[1,0,0]
    v_pk_fma_f32 v[150:151], v[150:151], v[26:27], v[252:253] op_sel_hi:[1,0,0] neg_lo:[0,0,1] neg_hi:[0,0,1]
    v_pk_fma_f32 v[168:169], v[152:153], v[26:27], v[254:255] op_sel_hi:[1,0,0] neg_lo:[1,0,0] neg_hi:[1,0,0]
    v_pk_fma_f32 v[152:153], v[152:153], v[26:27], v[252:253] op_sel_hi:[1,0,0] neg_lo:[0,0,1] neg_hi:[0,0,1]
    v_pk_fma_f32 v[170:171], v[154:155], v[26:27], v[254:255] op_sel_hi:[1,0,0] neg_lo:[1,0,0] neg_hi:[1,0,0]
    v_pk_fma_f32 v[154:155], v[154:155], v[26:27], v[252:253] op_sel_hi:[1,0,0] neg_lo:[0,0,1] neg_hi:[0,0,1]
    v_pk_fma_f32 v[172:173], v[156:157], v[26:27], v[6:7] op_sel_hi:[1,0,0] neg_lo:[1,0,0] neg_hi:[1,0,0]
    v_pk_fma_f32 v[156:157], v[156:157], v[26:27], v[30:31] op_sel_hi:[1,0,0] neg_lo:[0,0,1] neg_hi:[0,0,1]
    v_pk_fma_f32 v[174:175], v[158:159], v[26:27], v[6:7] op_sel_hi:[1,0,0] neg_lo:[1,0,0] neg_hi:[1,0,0]
    v_pk_fma_f32 v[158:159], v[158:159], v[26:27], v[30:31] op_sel_hi:[1,0,0] neg_lo:[0,0,1] neg_hi:[0,0,1]
    v_exp_f32 v144, v144
    v_exp_f32 v160, v160
    v_exp_f32 v145, v145
    s_waitcnt vmcnt(6)
    v_cmp_ne_u32 vcc, s52, v176
    s_nop 0
    s_cbranch_vccnz re_7
bk_8:
    s_lshr_b32 s89, s49, 1
    s_lshl_b32 s89, s89, 13
    buffer_load_dwordx4 v[32:35], v251, s[16:19], s89 offen offset:0 sc1
    v_exp_f32 v161, v161
    v_exp_f32 v146, v146
    buffer_load_dwordx4 v[36:39], v251, s[16:19], s89 offen offset:256 sc1
    v_exp_f32 v162, v162
    v_exp_f32 v147, v147
    v_exp_f32 v163, v163
    v_exp_f32 v148, v148
    v_exp_f32 v164, v164
    v_exp_f32 v149, v149
    s_add_u32 s89, s89, 8192
    s_and_b32 s89, s89, 0xffff
    buffer_load_dwordx4 v[40:43], v251, s[16:19], s89 offen offset:0 sc1
    v_exp_f32 v165, v165
    v_exp_f32 v150, v150
    v_exp_f32 v166, v166
    v_exp_f32 v151, v151
    buffer_load_dwordx4 v[44:47], v251, s[16:19], s89 offen offset:256 sc1
    v_exp_f32 v167, v167
    v_exp_f32 v152, v152
    v_exp_f32 v168, v168
    v_exp_f32 v153, v153
    v_exp_f32 v169, v169
    s_add_u32 s89, s89, 8192
    s_and_b32 s89, s89, 0xffff
    buffer_load_dwordx4 v[48:51], v251, s[16:19], s89 offen offset:0 sc1
    v_exp_f32 v154, v154
    v_exp_f32 v170, v170
    v_exp_f32 v155, v155
    v_exp_f32 v171, v171
    buffer_load_dwordx4 v[52:55], v251, s[16:19], s89 offen offset:256 sc1
    v_exp_f32 v156, v156
    v_exp_f32 v172, v172
    v_exp_f32 v157, v157
    v_exp_f32 v173, v173
    v_exp_f32 v158, v158
    s_add_u32 s89, s89, 8192
    s_and_b32 s89, s89, 0xffff
    buffer_load_dwordx4 v[56:59], v251, s[16:19], s89 offen offset:0 sc1
    v_exp_f32 v174, v174
    v_exp_f32 v159, v159
    v_exp_f32 v175, v175
    v_pk_add_f32 v[252:253], v[144:145], v[146:147]
    v_pk_add_f32 v[254:255], v[160:161], v[162:163]
    buffer_load_dwordx4 v[60:63], v251, s[16:19], s89 offen offset:256 sc1
    v_pk_add_f32 v[252:253], v[252:253], v[148:149]
    v_pk_add_f32 v[254:255], v[254:255], v[164:165]
    v_pk_add_f32 v[252:253], v[252:253], v[150:151]
    v_pk_add_f32 v[254:255], v[254:255], v[166:167]
    v_pk_add_f32 v[252:253], v[252:253], v[152:153]
    v_pk_add_f32 v[254:255], v[254:255], v[168:169]
    v_pk_add_f32 v[252:253], v[252:253], v[154:155]
    v_pk_add_f32 v[254:255], v[254:255], v[170:171]
    s_add_u32 s89, s89, 8192
    s_and_b32 s89, s89, 0xffff
    buffer_load_dwordx4 v[64:67], v251, s[16:19], s89 offen offset:0 sc1
    v_pk_add_f32 v[252:253], v[252:253], v[156:157]
    v_pk_add_f32 v[254:255], v[254:255], v[172:173]
    v_pk_add_f32 v[252:253], v[252:253], v[158:159]
    v_pk_add_f32 v[254:255], v[254:255], v[174:175]
    v_add_f32 v252, v252, v253
    v_add_f32 v254, v254, v255
    buffer_load_dwordx4 v[68:71], v251, s[16:19], s89 offen offset:256 sc1
    v_mov_b32 v23, v252
    v_mov_b32 v25, v254
    s_nop 0
    v_permlane32_swap_b32 v252, v23
    v_permlane32_swap_b32 v254, v25
    v_add_f32 v252, v252, v23
    v_add_f32 v254, v254, v25
    v_rcp_f32 v252, v252
    v_rcp_f32 v254, v254
    s_add_u32 s89, s89, 8192
    s_and_b32 s89, s89, 0xffff
    buffer_load_dwordx4 v[72:75], v251, s[16:19], s89 offen offset:0 sc1
    v_pk_mul_f32 v[144:145], v[144:145], v[252:253] op_sel_hi:[1,0]
    v_pk_mul_f32 v[160:161], v[160:161], v[254:255] op_sel_hi:[1,0]
    v_pk_mul_f32 v[146:147], v[146:147], v[252:253] op_sel_hi:[1,0]
    v_pk_mul_f32 v[162:163], v[162:163], v[254:255] op_sel_hi:[1,0]
    v_pk_mul_f32 v[148:149], v[148:149], v[252:253] op_sel_hi:[1,0]
    v_pk_mul_f32 v[164:165], v[164:165], v[254:255] op_sel_hi:[1,0]
    v_pk_mul_f32 v[150:151], v[150:151], v[252:253] op_sel_hi:[1,0]
    buffer_load_dwordx4 v[76:79], v251, s[16:19], s89 offen offset:256 sc1
    v_pk_mul_f32 v[166:167], v[166:167], v[254:255] op_sel_hi:[1,0]
    v_pk_mul_f32 v[152:153], v[152:153], v[252:253] op_sel_hi:[1,0]
    v_pk_mul_f32 v[168:169], v[168:169], v[254:255] op_sel_hi:[1,0]
    v_pk_mul_f32 v[154:155], v[154:155], v[252:253] op_sel_hi:[1,0]
    v_pk_mul_f32 v[170:171], v[170:171], v[254:255] op_sel_hi:[1,0]
    v_pk_mul_f32 v[156:157], v[156:157], v[252:253] op_sel_hi:[1,0]
    v_pk_mul_f32 v[172:173], v[172:173], v[254:255] op_sel_hi:[1,0]
    v_pk_mul_f32 v[158:159], v[158:159], v[252:253] op_sel_hi:[1,0]
    s_add_u32 s89, s89, 8192
    s_and_b32 s89, s89, 0xffff
    buffer_load_dwordx4 v[80:83], v251, s[16:19], s89 offen offset:0 sc1
    v_pk_mul_f32 v[174:175], v[174:175], v[254:255] op_sel_hi:[1,0]
    v_cvt_pk_bf16_f32 v192, v144, v145
    v_cvt_pk_bf16_f32 v193, v146, v147
    v_cvt_pk_bf16_f32 v194, v148, v149
    v_cvt_pk_bf16_f32 v195, v150, v151
    v_cvt_pk_bf16_f32 v196, v152, v153
    buffer_load_dwordx4 v[84:87], v251, s[16:19], s89 offen offset:256 sc1
    v_cvt_pk_bf16_f32 v197, v154, v155
    v_cvt_pk_bf16_f32 v198, v156, v157
    v_cvt_pk_bf16_f32 v199, v158, v159
    v_cvt_pk_bf16_f32 v200, v160, v161
    v_cvt_pk_bf16_f32 v201, v162, v163
    v_cvt_pk_bf16_f32 v202, v164, v165
    v_cvt_pk_bf16_f32 v203, v166, v167
    v_cvt_pk_bf16_f32 v204, v168, v169
    s_add_u32 s89, s89, 8192
    s_and_b32 s89, s89, 0xffff
    buffer_load_dwordx4 v[88:91], v251, s[16:19], s89 offen offset:0 sc1
    v_cvt_pk_bf16_f32 v205, v170, v171
    v_cvt_pk_bf16_f32 v206, v172, v173
    v_cvt_pk_bf16_f32 v207, v174, v175
    buffer_load_dwordx4 v[92:95], v251, s[16:19], s89 offen offset:256 sc1
    ds_read_b64_tr_b16 a[112:113], v234 offset:24576
    ds_read_b64_tr_b16 a[114:115], v234 offset:25600
    ds_read_b64_tr_b16 a[116:117], v235 offset:24576
    s_waitcnt vmcnt(15)
    v_mfma_f32_16x16x32_bf16 v[96:99], v[180:183], v[32:35], 0
    ds_read_b64_tr_b16 a[118:119], v235 offset:25600
    ds_read_b64_tr_b16 a[120:121], v234 offset:32768
    ds_read_b64_tr_b16 a[122:123], v234 offset:33792
    s_waitcnt vmcnt(14)
    v_mfma_f32_16x16x32_bf16 v[100:103], v[180:183], v[36:39], 0
    ds_read_b64_tr_b16 a[124:125], v235 offset:32768
    ds_read_b64_tr_b16 a[126:127], v235 offset:33792
    ds_read_b64_tr_b16 a[128:129], v234 offset:40960
    s_waitcnt vmcnt(13)
    v_mfma_f32_16x16x32_bf16 v[96:99], v[180:183], v[40:43], v[96:99]
    ds_read_b64_tr_b16 a[130:131], v234 offset:41984
    ds_read_b64_tr_b16 a[132:133], v235 offset:40960
    ds_read_b64_tr_b16 a[134:135], v235 offset:41984
    s_waitcnt vmcnt(12)
    v_mfma_f32_16x16x32_bf16 v[100:103], v[180:183], v[44:47], v[100:103]
    ds_read_b64_tr_b16 a[136:137], v236 offset:24576
    ds_read_b64_tr_b16 a[138:139], v236 offset:25600
    ds_read_b64_tr_b16 a[140:141], v237 offset:24576
    ds_read_b64_tr_b16 a[142:143], v237 offset:25600
    s_waitcnt vmcnt(11)
    v_mfma_f32_16x16x32_bf16 v[96:99], v[180:183], v[48:51], v[96:99]
    s_lshl2_add_u32 s53, s80, s48
    s_mul_i32 s53, s53, 56
    s_and_b32 s53, s53, -16
    s_mul_i32 s9, s79, 28672
    s_waitcnt vmcnt(10)
    v_mfma_f32_16x16x32_bf16 v[100:103], v[180:183], v[52:55], v[100:103]
    s_add_u32 s9, s9, s53
    v_lshrrev_b32 v30, 2, v1
    v_mul_u32_u24 v16, s87, v30
    v_and_b32 v31, 3, v1
    s_waitcnt vmcnt(9)
    v_mfma_f32_16x16x32_bf16 v[96:99], v[180:183], v[56:59], v[96:99]
    v_lshl_add_u32 v16, v31, 4, v16
    v_bfe_u32 v23, v1, 4, 1
    v_lshl_add_u32 v31, v23, 2, v31
    s_and_b32 s54, s48, 1
    s_waitcnt vmcnt(8)
    v_mfma_f32_16x16x32_bf16 v[100:103], v[180:183], v[60:63], v[100:103]
    v_add_u32 v31, s54, v31
    v_and_b32 v31, 7, v31
    v_lshlrev_b32 v31, 3, v31
    v_and_b32 v30, 3, v30
    s_waitcnt vmcnt(7)
    v_mfma_f32_16x16x32_bf16 v[96:99], v[180:183], v[64:67], v[96:99]
    v_lshl_add_u32 v31, v30, 6, v31
    v_lshrrev_b32 v23, 5, v1
    v_lshl_add_u32 v13, v23, 8, v31
    s_add_u32 s54, s90, 147456
    s_waitcnt vmcnt(6)
    v_mfma_f32_16x16x32_bf16 v[100:103], v[180:183], v[68:71], v[100:103]
    v_add_u32 v13, s54, v13
    s_add_u32 s100, s100, 4096
    buffer_load_dwordx4 a[64:67], v4, s[16:19], s100 offen offset:0 sc1
    buffer_load_dwordx4 a[68:71], v4, s[16:19], s100 offen offset:896 sc1
    buffer_load_dwordx4 a[72:75], v4, s[16:19], s100 offen offset:2048 sc1
    s_waitcnt vmcnt(8)
    v_mfma_f32_16x16x32_bf16 v[96:99], v[180:183], v[72:75], v[96:99]
    buffer_load_dwordx4 a[76:79], v4, s[16:19], s100 offen offset:2944 sc1
    s_add_u32 s100, s100, 4096
    buffer_load_dwordx4 a[80:83], v4, s[16:19], s100 offen offset:0 sc1
    buffer_load_dwordx4 a[84:87], v4, s[16:19], s100 offen offset:896 sc1
    buffer_load_dwordx4 a[88:91], v4, s[16:19], s100 offen offset:2048 sc1
    s_waitcnt vmcnt(11)
    v_mfma_f32_16x16x32_bf16 v[100:103], v[180:183], v[76:79], v[100:103]
    buffer_load_dwordx4 a[92:95], v4, s[16:19], s100 offen offset:2944 sc1
    s_add_u32 s100, s100, 4096
    buffer_load_dwordx4 a[96:99], v4, s[16:19], s100 offen offset:0 sc1
    buffer_load_dwordx4 a[100:103], v4, s[16:19], s100 offen offset:896 sc1
    buffer_load_dwordx4 a[104:107], v4, s[16:19], s100 offen offset:2048 sc1
    s_waitcnt vmcnt(14)
    v_mfma_f32_16x16x32_bf16 v[96:99], v[180:183], v[80:83], v[96:99]
    buffer_load_dwordx4 a[108:111], v4, s[16:19], s100 offen offset:2944 sc1
    s_add_u32 m0, s90, 147456
    s_nop 0
    buffer_load_dwordx4 v16, s[12:15], s9 offen lds
    s_add_u32 s88, s9, 13312
    buffer_load_dwordx4 v16, s[12:15], s88 offen offset:1024 lds
    s_waitcnt lgkmcnt(0)
    s_waitcnt vmcnt(16)
    v_mfma_f32_16x16x32_bf16 v[100:103], v[180:183], v[84:87], v[100:103]
    s_waitcnt vmcnt(15)
    v_mfma_f32_16x16x32_bf16 v[96:99], v[180:183], v[88:91], v[96:99]
    s_waitcnt vmcnt(14)
    v_mfma_f32_16x16x32_bf16 v[100:103], v[180:183], v[92:95], v[100:103]
    s_nop 7
    v_cmp_u_f32 vcc, v96, v100
    v_cvt_pk_bf16_f32 v112, v96, v97
    v_cvt_pk_bf16_f32 v113, v98, v99
    v_cvt_pk_bf16_f32 v114, v100, v101
    v_cvt_pk_bf16_f32 v115, v102, v103
    s_cbranch_vccnz kv_9
kvb_10:
    ds_write_b64 v184, v[112:113]
    ds_write_b64 v184, v[114:115] offset:256
    s_waitcnt lgkmcnt(0)
    s_barrier
    ds_read_b128 v[112:115], v185 offset:0
    ds_read_b128 v[116:119], v185 offset:1024
    ds_read_b128 v[120:123], v185 offset:2048
    ds_read_b128 v[124:127], v185 offset:3072
    s_waitcnt lgkmcnt(3)
    v_mfma_f32_32x32x16_bf16 v[128:143], v[112:115], v[192:195], 0
    s_waitcnt lgkmcnt(2)
    v_mfma_f32_32x32x16_bf16 v[128:143], v[116:119], v[196:199], v[128:143]
    s_waitcnt lgkmcnt(1)
    v_mfma_f32_32x32x16_bf16 v[128:143], v[120:123], v[200:203], v[128:143]
    s_waitcnt lgkmcnt(0)
    v_mfma_f32_32x32x16_bf16 v[128:143], v[124:127], v[204:207], v[128:143]
    s_nop 11
    v_mov_b32 v30, v140
    v_mov_b32 v31, v140
    s_nop 1
    v_permlane32_swap_b32 v30, v31
    v_add_f32 v31, 0x358637bd, v31
    v_rcp_f32 v30, v31
    s_nop 0
    v_pk_mul_f32 v[128:129], v[128:129], v[30:31] op_sel_hi:[1,0]
    v_pk_mul_f32 v[130:131], v[130:131], v[30:31] op_sel_hi:[1,0]
    v_pk_mul_f32 v[132:133], v[132:133], v[30:31] op_sel_hi:[1,0]
    v_pk_mul_f32 v[134:135], v[134:135], v[30:31] op_sel_hi:[1,0]
    v_pk_mul_f32 v[136:137], v[136:137], v[30:31] op_sel_hi:[1,0]
    v_pk_mul_f32 v[138:139], v[138:139], v[30:31] op_sel_hi:[1,0]
    v_pk_mul_f32 v[140:141], v[140:141], v[30:31] op_sel_hi:[1,0]
    v_pk_mul_f32 v[142:143], v[142:143], v[30:31] op_sel_hi:[1,0]
    v_cvt_pk_bf16_f32 v112, v128, v129
    v_cvt_pk_bf16_f32 v113, v130, v131
    v_cvt_pk_bf16_f32 v114, v132, v133
    v_cvt_pk_bf16_f32 v115, v134, v135
    buffer_store_dwordx4 v[112:115], v238, s[16:19], s94 offen sc1
    v_cvt_pk_bf16_f32 v116, v136, v137
    v_cvt_pk_bf16_f32 v117, v138, v139
    v_cvt_pk_bf16_f32 v118, v140, v141
    v_cvt_pk_bf16_f32 v119, v142, v143
    buffer_store_dwordx4 v[116:119], v239, s[16:19], s94 offen sc1
    buffer_store_dwordx2 v[116:117], v249, s[16:19], s94 offen sc1
    s_add_u32 m0, s90, 90112
    s_nop 0
    buffer_load_dwordx4 v9, s[24:27], s65 offen lds
    buffer_load_dwordx4 v10, s[24:27], s65 offen offset:1024 lds
    s_add_u32 m0, s90, 98304
    s_add_u32 s88, s65, 57344
    buffer_load_dwordx4 v9, s[24:27], s88 offen lds
    buffer_load_dwordx4 v10, s[24:27], s88 offen offset:1024 lds
    s_add_u32 m0, s90, 106496
    s_add_u32 s88, s65, 114688
    buffer_load_dwordx4 v9, s[24:27], s88 offen lds
    buffer_load_dwordx4 v10, s[24:27], s88 offen offset:1024 lds
    s_add_u32 m0, s90, 0
    s_add_u32 s88, s65, 172032
    buffer_load_dwordx4 v9, s[24:27], s88 offen lds
    buffer_load_dwordx4 v10, s[24:27], s88 offen offset:1024 lds
    s_add_u32 m0, s90, 8192
    s_nop 0
    buffer_load_dwordx4 v9, s[24:27], s66 offen lds
    buffer_load_dwordx4 v10, s[24:27], s66 offen offset:1024 lds
    s_add_u32 m0, s90, 16384
    s_add_u32 s88, s66, 57344
    buffer_load_dwordx4 v9, s[24:27], s88 offen lds
    buffer_load_dwordx4 v10, s[24:27], s88 offen offset:1024 lds
    s_add_u32 m0, s90, 24576
    s_add_u32 s88, s66, 114688
    buffer_load_dwordx4 v9, s[24:27], s88 offen lds
    buffer_load_dwordx4 v10, s[24:27], s88 offen offset:1024 lds
    s_add_u32 m0, s90, 32768
    s_add_u32 s88, s66, 172032
    buffer_load_dwordx4 v9, s[24:27], s88 offen lds
    buffer_load_dwordx4 v10, s[24:27], s88 offen offset:1024 lds
    s_add_u32 m0, s90, 40960
    s_nop 0
    buffer_load_dwordx4 v9, s[24:27], s67 offen lds
    buffer_load_dwordx4 v10, s[24:27], s67 offen offset:1024 lds
    s_add_u32 m0, s90, 49152
    s_add_u32 s88, s67, 57344
    buffer_load_dwordx4 v9, s[24:27], s88 offen lds
    buffer_load_dwordx4 v10, s[24:27], s88 offen offset:1024 lds
    s_waitcnt vmcnt(23)
    ds_read_b64_tr_b16 v[168:169], v13 offset:0
    ds_read_b64_tr_b16 v[170:171], v13 offset:512
    ds_read_b64_tr_b16 v[172:173], v13 offset:1024
    ds_read_b64_tr_b16 v[174:175], v13 offset:1536
    s_add_u32 s53, s48, 1
    s_and_b32 s53, s53, 3
    s_mul_i32 s53, s53, 6144
    s_add_u32 s53, s53, 114688
    v_add_u32 v17, s53, v3
    s_add_u32 s53, s48, 2
    s_and_b32 s53, s53, 3
    s_mul_i32 s53, s53, 6144
    s_add_u32 s53, s53, 116736
    v_add_u32 v18, s53, v3
    s_add_u32 s53, s48, 3
    s_and_b32 s53, s53, 3
    s_mul_i32 s53, s53, 6144
    s_add_u32 s53, s53, 118784
    v_add_u32 v19, s53, v3
    s_mul_i32 s53, s48, 6144
    s_add_u32 s53, s53, 114688
    v_add_u32 v14, s53, v3
    s_lshl2_add_u32 s53, s97, s48
    s_mul_i32 s54, s53, 917504
    s_lshl_b32 s55, s86, 7
    s_add_u32 s54, s54, s55
    s_lshl1_add_u32 s55, s85, s86
    s_mul_i32 s57, s55, 37
    s_lshr_b32 s57, s57, 8
    s_mul_i32 s57, s57, 7
    s_sub_u32 s55, s55, s57
    s_mul_i32 s46, s55, 1792
    s_lshl_b32 s71, s55, 17
    s_add_u32 s71, s71, s54
    s_add_u32 s55, s55, 1
    s_cmp_eq_u32 s55, 7
    s_cselect_b32 s55, 0, s55
    s_mul_i32 s47, s55, 1792
    s_lshl_b32 s72, s55, 17
    s_add_u32 s72, s72, s54
    s_add_u32 s55, s55, 1
    s_cmp_eq_u32 s55, 7
    s_cselect_b32 s55, 0, s55
    s_mul_i32 s91, s55, 1792
    s_lshl_b32 s73, s55, 17
    s_add_u32 s73, s73, s54
    s_add_u32 s55, s55, 1
    s_cmp_eq_u32 s55, 7
    s_cselect_b32 s55, 0, s55
    s_mul_i32 s92, s55, 1792
    s_lshl_b32 s74, s55, 17
    s_add_u32 s74, s74, s54
    s_add_u32 s55, s55, 1
    s_cmp_eq_u32 s55, 7
    s_cselect_b32 s55, 0, s55
    s_mul_i32 s51, s55, 1792
    s_lshl_b32 s75, s55, 17
    s_add_u32 s75, s75, s54
    s_add_u32 s55, s55, 1
    s_cmp_eq_u32 s55, 7
    s_cselect_b32 s55, 0, s55
    s_mul_i32 s62, s55, 1792
    s_lshl_b32 s76, s55, 17
    s_add_u32 s76, s76, s54
    s_add_u32 s55, s55, 1
    s_cmp_eq_u32 s55, 7
    s_cselect_b32 s55, 0, s55
    s_mul_i32 s100, s55, 1792
    s_lshl_b32 s77, s55, 17
    s_add_u32 s77, s77, s54
    s_lshl2_add_u32 s53, s97, s48
    v_bfe_u32 v30, v1, 2, 1
    s_lshl_b32 s54, s53, 1
    v_add_u32 v30, s54, v30
    v_lshrrev_b32 v31, 2, v30
    v_and_b32 v30, 3, v30
    v_lshl_add_u32 v31, v30, 6, v31
    v_and_b32 v30, 2, v1
    v_lshl_add_u32 v31, v30, 1, v31
    v_and_b32 v30, 1, v1
    v_lshl_add_u32 v31, v30, 5, v31
    s_and_b32 s54, s83, 3
    s_lshl_b32 s54, s54, 3
    v_add_u32 v31, s54, v31
    s_mul_i32 s53, s53, 14
    v_and_b32 v30, 7, v1
    v_lshlrev_b32 v30, 1, v30
    v_min_u32 v30, 13, v30
    v_add_u32 v30, s53, v30
    v_lshrrev_b32 v30, 2, v30
    v_mul_u32_u24 v23, 37, v30
    v_lshrrev_b32 v23, 8, v23
    v_lshlrev_b32 v30, 3, v30
    v_mul_u32_u24 v25, 55, v23
    v_sub_u32 v30, v30, v25
    v_and_b32 v23, 8, v1
    v_lshrrev_b32 v23, 1, v23
    s_mul_i32 s54, s85, 56
    v_add3_u32 v30, v30, v23, s54
    v_cmp_lt_u32 vcc, 15, v2
    s_nop 1
    v_cndmask_b32 v31, v31, v30, vcc
    v_lshlrev_b32 v5, 7, v31
    buffer_load_dword v27, v5, s[16:19], s101 offen sc1
    s_add_u32 s54, s5, 4096
    v_add_u32 v31, 114688, v3
    s_mul_i32 s53, s48, 7168
    v_add_u32 v30, s53, v31
    s_waitcnt lgkmcnt(0)
    v_lshlrev_b32 v144, 16, v168
    v_and_b32 v145, 0xffff0000, v168
    v_lshlrev_b32 v146, 16, v169
    v_and_b32 v147, 0xffff0000, v169
    v_lshlrev_b32 v148, 16, v170
    v_and_b32 v149, 0xffff0000, v170
    v_lshlrev_b32 v150, 16, v171
    v_and_b32 v151, 0xffff0000, v171
    v_lshlrev_b32 v152, 16, v172
    v_and_b32 v153, 0xffff0000, v172
    v_lshlrev_b32 v154, 16, v173
    v_and_b32 v155, 0xffff0000, v173
    v_lshlrev_b32 v156, 16, v174
    v_and_b32 v157, 0xffff0000, v174
    v_lshlrev_b32 v158, 16, v175
    v_and_b32 v159, 0xffff0000, v175
ol_28:
    buffer_load_dwordx4 v[32:35], v3, s[16:19], s5 offen offset:0 sc1
    buffer_load_dwordx4 v[36:39], v3, s[16:19], s5 offen offset:1024 sc1
    buffer_load_dwordx4 v[40:43], v3, s[16:19], s5 offen offset:2048 sc1
    buffer_load_dwordx4 v[44:47], v3, s[16:19], s5 offen offset:3072 sc1
    buffer_load_dwordx4 v[48:51], v3, s[16:19], s54 offen offset:0 sc1
    buffer_load_dwordx4 v[52:55], v3, s[16:19], s54 offen offset:1024 sc1
    buffer_load_dwordx4 v[56:59], v3, s[16:19], s54 offen offset:2048 sc1
    s_waitcnt vmcnt(6)
    v_max3_u32 v23, v32, v33, v34
    v_max_u32 v23, v23, v35
    s_waitcnt vmcnt(5)
    v_max3_u32 v23, v23, v36, v37
    v_max3_u32 v23, v23, v38, v39
    s_waitcnt vmcnt(4)
    v_max3_u32 v23, v23, v40, v41
    v_max3_u32 v23, v23, v42, v43
    s_waitcnt vmcnt(3)
    v_max3_u32 v23, v23, v44, v45
    v_max3_u32 v23, v23, v46, v47
    s_waitcnt vmcnt(2)
    v_max3_u32 v23, v23, v48, v49
    v_max3_u32 v23, v23, v50, v51
    s_waitcnt vmcnt(1)
    v_max3_u32 v23, v23, v52, v53
    v_max3_u32 v23, v23, v54, v55
    s_waitcnt vmcnt(0)
    v_max3_u32 v23, v23, v56, v57
    v_max3_u32 v23, v23, v58, v59
    v_cmp_eq_u32 vcc, -1, v23
    s_nop 0
    s_cbranch_vccnz olp_29
olb_30:
    v_cmp_ne_u32 vcc, s52, v27
    s_nop 0
    s_cbranch_vccnz re_33
bk_34:
    ds_write_b128 v30, v[32:35] offset:0
    ds_write_b128 v30, v[36:39] offset:1024
    ds_write_b128 v30, v[40:43] offset:2048
    ds_write_b128 v30, v[44:47] offset:3072
    ds_write_b128 v30, v[48:51] offset:4096
    ds_write_b128 v30, v[52:55] offset:5120
    ds_write_b128 v30, v[56:59] offset:6144
    s_waitcnt lgkmcnt(0)
    s_barrier
    ds_read_b128 v[60:63], v31 offset:0
    s_add_u32 m0, s90, 57344
    s_add_u32 s88, s67, 114688
    buffer_load_dwordx4 v9, s[24:27], s88 offen lds
    buffer_load_dwordx4 v10, s[24:27], s88 offen offset:1024 lds
    ds_read_b128 v[64:67], v31 offset:1024
    ds_read_b128 v[68:71], v31 offset:2048
    ds_read_b128 v[72:75], v31 offset:3072
    ds_read_b128 v[76:79], v31 offset:4096
    ds_read_b128 v[80:83], v31 offset:5120
    ds_read_b128 v[84:87], v31 offset:6144
    ds_read_b128 v[88:91], v31 offset:7168
    s_waitcnt lgkmcnt(7)
    v_mfma_f32_32x32x16_bf16 v[144:159], v[60:63], a[0:3], v[144:159]
    ds_read_b64_tr_b16 a[144:145], v234 offset:24576
    ds_read_b64_tr_b16 a[146:147], v234 offset:25600
    ds_read_b64_tr_b16 a[148:149], v235 offset:24576
    s_waitcnt lgkmcnt(9)
    v_mfma_f32_32x32x16_bf16 v[144:159], v[64:67], a[4:7], v[144:159]
    ds_read_b64_tr_b16 a[150:151], v235 offset:25600
    ds_read_b64_tr_b16 a[152:153], v234 offset:32768
    ds_read_b128 v[60:63], v31 offset:8192
    s_waitcnt lgkmcnt(11)
    v_mfma_f32_32x32x16_bf16 v[144:159], v[68:71], a[8:11], v[144:159]
    s_add_u32 m0, s90, 65536
    s_add_u32 s88, s67, 172032
    buffer_load_dwordx4 v9, s[24:27], s88 offen lds
    buffer_load_dwordx4 v10, s[24:27], s88 offen offset:1024 lds
    ds_read_b128 v[64:67], v31 offset:9216
    s_waitcnt lgkmcnt(11)
    v_mfma_f32_32x32x16_bf16 v[144:159], v[72:75], a[12:15], v[144:159]
    ds_read_b64_tr_b16 a[154:155], v234 offset:33792
    ds_read_b64_tr_b16 a[156:157], v235 offset:32768
    ds_read_b64_tr_b16 a[158:159], v235 offset:33792
    ds_read_b128 v[68:71], v31 offset:10240
    s_waitcnt lgkmcnt(14)
    v_mfma_f32_32x32x16_bf16 v[144:159], v[76:79], a[16:19], v[144:159]
    ds_read_b64_tr_b16 a[160:161], v234 offset:40960
    ds_read_b64_tr_b16 a[162:163], v234 offset:41984
    ds_read_b128 v[72:75], v31 offset:11264
    s_waitcnt lgkmcnt(15)
    v_mfma_f32_32x32x16_bf16 v[144:159], v[80:83], a[20:23], v[144:159]
    s_add_u32 m0, s90, 73728
    s_nop 0
    buffer_load_dwordx4 v11, s[28:31], s71 offen lds
    buffer_load_dwordx4 v12, s[28:31], s71 offen offset:1024 lds
    ds_read_b128 v[76:79], v31 offset:12288
    v_mfma_f32_32x32x16_bf16 v[144:159], v[84:87], a[24:27], v[144:159]
    ds_read_b64_tr_b16 a[164:165], v235 offset:40960
    ds_read_b64_tr_b16 a[166:167], v235 offset:41984
    ds_read_b128 v[80:83], v31 offset:13312
    s_waitcnt lgkmcnt(15)
    v_mfma_f32_32x32x16_bf16 v[144:159], v[88:91], a[28:31], v[144:159]
    ds_read_b64_tr_b16 a[168:169], v232 offset:0
    ds_read_b64_tr_b16 a[170:171], v232 offset:1024
    ds_read_b64_tr_b16 a[172:173], v233 offset:0
    ds_read_b128 v[84:87], v31 offset:14336
    s_waitcnt lgkmcnt(15)
    v_mfma_f32_32x32x16_bf16 v[144:159], v[60:63], a[32:35], v[144:159]
    ds_read_b64_tr_b16 a[174:175], v233 offset:1024
    ds_read_b64_tr_b16 a[176:177], v232 offset:8192
    ds_read_b128 v[88:91], v31 offset:15360
    v_mfma_f32_32x32x16_bf16 v[144:159], v[64:67], a[36:39], v[144:159]
    s_add_u32 m0, s90, 81920
    s_add_u32 s88, s71, 65536
    buffer_load_dwordx4 v11, s[28:31], s88 offen lds
    buffer_load_dwordx4 v12, s[28:31], s88 offen offset:1024 lds
    ds_read_b128 v[60:63], v31 offset:16384
    s_waitcnt lgkmcnt(15)
    v_mfma_f32_32x32x16_bf16 v[144:159], v[68:71], a[40:43], v[144:159]
    ds_read_b64_tr_b16 a[178:179], v232 offset:9216
    ds_read_b64_tr_b16 a[180:181], v233 offset:8192
    ds_read_b64_tr_b16 a[182:183], v233 offset:9216
    ds_read_b128 v[64:67], v31 offset:17408
    s_waitcnt lgkmcnt(15)
    v_mfma_f32_32x32x16_bf16 v[144:159], v[72:75], a[44:47], v[144:159]
    ds_read_b64_tr_b16 a[184:185], v232 offset:16384
    ds_read_b64_tr_b16 a[186:187], v232 offset:17408
    ds_read_b128 v[68:71], v31 offset:18432
    v_mfma_f32_32x32x16_bf16 v[144:159], v[76:79], a[48:51], v[144:159]
    ds_read_b64_tr_b16 a[188:189], v233 offset:16384
    ds_read_b64_tr_b16 a[190:191], v233 offset:17408
    ds_read_b128 v[72:75], v31 offset:19456
    s_waitcnt lgkmcnt(15)
    v_mfma_f32_32x32x16_bf16 v[144:159], v[80:83], a[52:55], v[144:159]
    ds_read_b64_tr_b16 a[192:193], v232 offset:24576
    ds_read_b64_tr_b16 a[194:195], v232 offset:25600
    ds_read_b64_tr_b16 a[196:197], v233 offset:24576
    ds_read_b128 v[76:79], v31 offset:20480
    s_waitcnt lgkmcnt(15)
    v_mfma_f32_32x32x16_bf16 v[144:159], v[84:87], a[56:59], v[144:159]
    ds_read_b64_tr_b16 a[198:199], v233 offset:25600
    ds_read_b64_tr_b16 a[200:201], v232 offset:32768
    ds_read_b128 v[80:83], v31 offset:21504
    v_mfma_f32_32x32x16_bf16 v[144:159], v[88:91], a[60:63], v[144:159]
    ds_read_b64_tr_b16 a[202:203], v232 offset:33792
    ds_read_b64_tr_b16 a[204:205], v233 offset:32768
    ds_read_b64_tr_b16 a[206:207], v233 offset:33792
    ds_read_b128 v[84:87], v31 offset:22528
    s_waitcnt lgkmcnt(15)
    v_mfma_f32_32x32x16_bf16 v[144:159], v[60:63], a[64:67], v[144:159]
    ds_read_b64_tr_b16 a[208:209], v232 offset:40960
    ds_read_b64_tr_b16 a[210:211], v232 offset:41984
    ds_read_b128 v[88:91], v31 offset:23552
    v_mfma_f32_32x32x16_bf16 v[144:159], v[64:67], a[68:71], v[144:159]
    ds_read_b64_tr_b16 a[212:213], v233 offset:40960
    ds_read_b64_tr_b16 a[214:215], v233 offset:41984
    ds_read_b128 v[60:63], v31 offset:24576
    s_waitcnt lgkmcnt(15)
    v_mfma_f32_32x32x16_bf16 v[144:159], v[68:71], a[72:75], v[144:159]
    ds_read_b64_tr_b16 a[216:217], v232 offset:49152
    ds_read_b64_tr_b16 a[218:219], v232 offset:50176
    ds_read_b64_tr_b16 a[220:221], v233 offset:49152
    ds_read_b128 v[64:67], v31 offset:25600
    v_mfma_f32_32x32x16_bf16 v[144:159], v[72:75], a[76:79], v[144:159]
    ds_read_b64_tr_b16 a[222:223], v233 offset:50176
    ds_read_b128 v[68:71], v31 offset:26624
    s_waitcnt lgkmcnt(15)
    v_mfma_f32_32x32x16_bf16 v[144:159], v[76:79], a[80:83], v[144:159]
    ds_read_b128 v[72:75], v31 offset:27648
    v_mfma_f32_32x32x16_bf16 v[144:159], v[80:83], a[84:87], v[144:159]
    s_waitcnt lgkmcnt(13)
    v_mfma_f32_32x32x16_bf16 v[144:159], v[84:87], a[88:91], v[144:159]
    s_waitcnt lgkmcnt(10)
    v_mfma_f32_32x32x16_bf16 v[144:159], v[88:91], a[92:95], v[144:159]
    s_waitcnt lgkmcnt(7)
    v_mfma_f32_32x32x16_bf16 v[144:159], v[60:63], a[96:99], v[144:159]
    s_waitcnt lgkmcnt(3)
    v_mfma_f32_32x32x16_bf16 v[144:159], v[64:67], a[100:103], v[144:159]
    s_waitcnt lgkmcnt(1)
    v_mfma_f32_32x32x16_bf16 v[144:159], v[68:71], a[104:107], v[144:159]
    s_waitcnt lgkmcnt(0)
    v_mfma_f32_32x32x16_bf16 v[144:159], v[72:75], a[108:111], v[144:159]
    s_nop 11
    v_cvt_pk_bf16_f32 v208, v144, v145
    v_cvt_pk_bf16_f32 v209, v146, v147
    v_cvt_pk_bf16_f32 v210, v148, v149
    v_cvt_pk_bf16_f32 v211, v150, v151
    v_cvt_pk_bf16_f32 v212, v152, v153
    v_cvt_pk_bf16_f32 v213, v154, v155
    v_cvt_pk_bf16_f32 v214, v156, v157
    v_cvt_pk_bf16_f32 v215, v158, v159
    v_mfma_f32_32x32x16_bf16 v[96:111], v[208:211], v[240:243], 0
    s_nop 0
    v_mfma_f32_32x32x16_bf16 v[96:111], v[212:215], v[244:247], v[96:111]
    s_lshl2_add_u32 s53, s48, 155648
    v_add_u32 v30, s53, v3
    v_lshlrev_b32 v142, 4, v2
    v_add_u32 v142, 155648, v142
    v_mov_b32 v129, s52
    v_mov_b32 v131, s52
    s_cmp_eq_u32 s48, 0
    s_cselect_b32 s55, 0, 2147483648
    v_mov_b32 v23, 2147483648
    v_cndmask_b32 v31, v3, v23, s[60:61]
    v_or_b32 v31, s55, v31
    s_nop 0
    v_cndmask_b32 v108, v108, 0, s[60:61]
    v_cndmask_b32 v109, v109, 0, s[60:61]
    v_cndmask_b32 v110, v110, 0, s[60:61]
    v_cndmask_b32 v111, v111, 0, s[60:61]
    v_pk_add_f32 v[24:25], v[96:97], v[98:99]
    v_pk_mul_f32 v[26:27], v[96:97], v[96:97]
    v_pk_fma_f32 v[26:27], v[98:99], v[98:99], v[26:27]
    v_pk_add_f32 v[24:25], v[24:25], v[100:101]
    v_pk_fma_f32 v[26:27], v[100:101], v[100:101], v[26:27]
    v_pk_add_f32 v[24:25], v[24:25], v[102:103]
    v_pk_fma_f32 v[26:27], v[102:103], v[102:103], v[26:27]
    v_pk_add_f32 v[24:25], v[24:25], v[104:105]
    v_pk_fma_f32 v[26:27], v[104:105], v[104:105], v[26:27]
    v_pk_add_f32 v[24:25], v[24:25], v[106:107]
    v_pk_fma_f32 v[26:27], v[106:107], v[106:107], v[26:27]
    v_pk_add_f32 v[24:25], v[24:25], v[108:109]
    v_pk_fma_f32 v[26:27], v[108:109], v[108:109], v[26:27]
    v_pk_add_f32 v[24:25], v[24:25], v[110:111]
    v_pk_fma_f32 v[26:27], v[110:111], v[110:111], v[26:27]
    v_add_f32 v24, v24, v25
    v_add_f32 v26, v26, v27
    s_nop 1
    v_permlane32_swap_b32 v24, v26
    v_add_f32 v24, v24, v26
    ds_write_b32 v30, v24
    s_waitcnt lgkmcnt(0)
    s_barrier
    ds_read_b128 v[132:135], v142
    ds_read_b128 v[136:139], v142 offset:512
    s_waitcnt lgkmcnt(1)
    v_pk_add_f32 v[132:133], v[132:133], v[134:135]
    s_waitcnt lgkmcnt(0)
    v_pk_add_f32 v[136:137], v[136:137], v[138:139]
    v_add_f32 v128, v132, v133
    v_add_f32 v130, v136, v137
    buffer_store_dwordx4 v[128:131], v31, s[16:19], s7 offen sc1
    s_lshl2_add_u32 s53, s84, s48
    s_lshl_b32 s53, s53, 5
    v_lshrrev_b32 v23, 5, v1
    v_lshlrev_b32 v23, 3, v23
    buffer_load_dwordx2 v[216:217], v23, s[32:35], s53 offen
    buffer_load_dwordx2 v[218:219], v23, s[32:35], s53 offen offset:16
    s_lshl2_add_u32 s53, s86, s48
    s_lshl_b32 s53, s53, 5
    v_lshrrev_b32 v23, 5, v1
    v_lshlrev_b32 v23, 3, v23
    buffer_load_dwordx2 v[220:221], v23, s[36:39], s53 offen
    buffer_load_dwordx2 v[222:223], v23, s[36:39], s53 offen offset:16
    v_lshlrev_b32 v144, 16, v208
    v_and_b32 v145, 0xffff0000, v208
    v_lshlrev_b32 v146, 16, v209
    v_and_b32 v147, 0xffff0000, v209
    v_lshlrev_b32 v148, 16, v210
    v_and_b32 v149, 0xffff0000, v210
    v_lshlrev_b32 v150, 16, v211
    v_and_b32 v151, 0xffff0000, v211
    v_lshlrev_b32 v152, 16, v212
    v_and_b32 v153, 0xffff0000, v212
    v_lshlrev_b32 v154, 16, v213
    v_and_b32 v155, 0xffff0000, v213
    v_lshlrev_b32 v156, 16, v214
    v_and_b32 v157, 0xffff0000, v214
    v_lshlrev_b32 v158, 16, v215
    v_and_b32 v159, 0xffff0000, v215
    s_lshl_b32 s53, s48, 8
    s_add_u32 s53, s53, 156672
    v_lshlrev_b32 v140, 2, v1
    v_add_u32 v140, s53, v140
    v_lshrrev_b32 v141, 5, v1
    v_lshlrev_b32 v141, 4, v141
    v_add_u32 v141, s53, v141
    s_waitcnt vmcnt(11)
    ds_read_b64_tr_b16 a[224:225], v232 offset:57344
    ds_read_b64_tr_b16 a[226:227], v232 offset:58368
    ds_read_b64_tr_b16 a[228:229], v233 offset:57344
    ds_read_b64_tr_b16 a[230:231], v233 offset:58368
    s_waitcnt vmcnt(9)
    ds_read_b64_tr_b16 a[232:233], v234 offset:0
    ds_read_b64_tr_b16 a[234:235], v234 offset:1024
    ds_read_b64_tr_b16 a[236:237], v235 offset:0
    ds_read_b64_tr_b16 a[238:239], v235 offset:1024
    s_waitcnt vmcnt(7)
    ds_read_b64_tr_b16 a[0:1], v234 offset:8192
    ds_read_b64_tr_b16 a[2:3], v234 offset:9216
    ds_read_b64_tr_b16 a[4:5], v235 offset:8192
    ds_read_b64_tr_b16 a[6:7], v235 offset:9216
    s_waitcnt vmcnt(5)
    ds_read_b64_tr_b16 a[8:9], v234 offset:16384
    ds_read_b64_tr_b16 a[10:11], v234 offset:17408
    ds_read_b64_tr_b16 a[12:13], v235 offset:16384
    ds_read_b64_tr_b16 a[14:15], v235 offset:17408
st_35:
    buffer_load_dwordx4 v[132:135], v3, s[16:19], s8 offen sc1
    buffer_load_dwordx4 v[136:139], v3, s[16:19], s8 offen offset:1024 sc1
    s_waitcnt vmcnt(0)
    v_xor_b32 v30, s52, v133
    v_xor_b32 v31, s52, v135
    v_xor_b32 v23, s52, v137
    v_or3_b32 v30, v30, v31, v23
    v_xor_b32 v31, s52, v139
    v_or_b32 v30, v30, v31
    v_cmp_ne_u32 vcc, 0, v30
    s_nop 0
    s_cbranch_vccz ok_36
    s_add_u32 s78, s78, 1
    s_cmp_lt_u32 s78, 0x8000
    s_cbranch_scc1 st_35
ok_36:
    v_add_f32 v24, v132, v136
    v_add_f32 v26, v134, v138
    v_mov_b32 v30, v24
    v_mov_b32 v31, v26
    s_nop 0
    v_permlane32_swap_b32 v24, v30
    v_permlane32_swap_b32 v26, v31
    v_add_f32 v24, v24, v30
    v_add_f32 v26, v26, v31
    v_mul_f32 v24, 0xbb124925, v24
    v_mul_f32 v30, v24, v24
    v_mov_b32 v31, 0x3b124925
    v_fma_f32 v30, v26, v31, -v30
    v_max_f32 v30, 0, v30
    v_add_f32 v31, 0x3727c5ac, v30
    v_rsq_f32 v31, v31
    s_nop 0
    v_mul_f32 v30, v30, v31
    v_mul_f32 v30, v30, v31
    v_add_f32 v30, 0x3727c5ac, v30
    v_rsq_f32 v30, v30
    s_nop 0
    v_mul_f32 v30, v30, v31
    v_mul_f32 v24, v24, v30
    v_cndmask_b32 v30, v30, v24, s[60:61]
    ds_write_b32 v140, v30
    s_waitcnt lgkmcnt(0)
    ds_read_b128 v[64:67], v141 offset:0
    ds_read_b128 v[80:83], v141 offset:128
    ds_read_b128 v[68:71], v141 offset:32
    ds_read_b128 v[84:87], v141 offset:160
    ds_read_b128 v[72:75], v141 offset:64
    ds_read_b128 v[88:91], v141 offset:192
    ds_read_b128 v[76:79], v141 offset:96
    ds_read_b128 v[92:95], v141 offset:224
    s_waitcnt lgkmcnt(6)
    v_pk_fma_f32 v[144:145], v[144:145], v[64:65], v[80:81]
    v_pk_fma_f32 v[146:147], v[146:147], v[66:67], v[82:83]
    v_cvt_pk_bf16_f32 v168, v144, v145
    v_cvt_pk_bf16_f32 v169, v146, v147
    s_waitcnt lgkmcnt(4)
    v_pk_fma_f32 v[148:149], v[148:149], v[68:69], v[84:85]
    v_pk_fma_f32 v[150:151], v[150:151], v[70:71], v[86:87]
    v_cvt_pk_bf16_f32 v170, v148, v149
    v_cvt_pk_bf16_f32 v171, v150, v151
    buffer_store_dwordx4 v[168:171], v4, s[16:19], s95 offen offset:0 sc1
    s_waitcnt lgkmcnt(2)
    v_pk_fma_f32 v[152:153], v[152:153], v[72:73], v[88:89]
    v_pk_fma_f32 v[154:155], v[154:155], v[74:75], v[90:91]
    v_cvt_pk_bf16_f32 v172, v152, v153
    v_cvt_pk_bf16_f32 v173, v154, v155
    s_waitcnt lgkmcnt(0)
    v_pk_fma_f32 v[156:157], v[156:157], v[76:77], v[92:93]
    v_pk_fma_f32 v[158:159], v[158:159], v[78:79], v[94:95]
    v_cvt_pk_bf16_f32 v174, v156, v157
    v_cvt_pk_bf16_f32 v175, v158, v159
    buffer_store_dwordx4 v[172:175], v4, s[16:19], s95 offen offset:896 sc1
    s_add_u32 s79, s95, 1835008
    s_add_u32 m0, s90, 90112
    s_nop 0
    buffer_load_dwordx4 v11, s[28:31], s72 offen lds
    buffer_load_dwordx4 v12, s[28:31], s72 offen offset:1024 lds
    s_add_u32 m0, s90, 98304
    s_add_u32 s88, s72, 65536
    buffer_load_dwordx4 v11, s[28:31], s88 offen lds
    buffer_load_dwordx4 v12, s[28:31], s88 offen offset:1024 lds
    s_add_u32 m0, s90, 106496
    s_nop 0
    buffer_load_dwordx4 v11, s[28:31], s73 offen lds
    buffer_load_dwordx4 v12, s[28:31], s73 offen offset:1024 lds
    s_add_u32 m0, s90, 0
    s_add_u32 s88, s73, 65536
    buffer_load_dwordx4 v11, s[28:31], s88 offen lds
    buffer_load_dwordx4 v12, s[28:31], s88 offen offset:1024 lds
    v_lshlrev_b32 v192, 16, v216
    v_and_b32 v193, 0xffff0000, v216
    v_lshlrev_b32 v194, 16, v217
    v_and_b32 v195, 0xffff0000, v217
    v_lshlrev_b32 v196, 16, v218
    v_and_b32 v197, 0xffff0000, v218
    v_lshlrev_b32 v198, 16, v219
    v_and_b32 v199, 0xffff0000, v219
    v_lshlrev_b32 v200, 16, v220
    v_and_b32 v201, 0xffff0000, v220
    v_lshlrev_b32 v202, 16, v221
    v_and_b32 v203, 0xffff0000, v221
    v_lshlrev_b32 v204, 16, v222
    v_and_b32 v205, 0xffff0000, v222
    v_lshlrev_b32 v206, 16, v223
    v_and_b32 v207, 0xffff0000, v223
    s_waitcnt lgkmcnt(0)
    s_lshl_b32 s53, s83, 5
    s_lshl2_add_u32 s54, s97, s48
    s_add_u32 s53, s53, s54
    s_mul_i32 s53, s53, 14336
    s_add_u32 s55, s53, 5767168
    s_mul_i32 s54, s97, 229376
    s_add_u32 s6, s55, s54
    s_add_u32 s7, s6, 114688
    s_sub_u32 s4, s55, s54
    s_add_u32 s4, s4, 229376
    s_add_u32 s5, s4, 114688
    s_lshl_b32 s53, s85, 5
    s_lshl2_add_u32 s54, s97, s48
    s_add_u32 s53, s53, s54
    s_mul_i32 s53, s53, 12544
    s_add_u32 s22, s53, 9437184
    s_mul_i32 s54, s97, 200704
    s_add_u32 s20, s22, s54
    s_add_u32 s21, s20, 100352
    s_sub_u32 s8, s22, s54
    s_add_u32 s8, s8, 200704
    s_add_u32 s9, s8, 100352
    s_add_u32 s95, s22, 100352
    s_lshl2_add_u32 s10, s2, s48
    s_lshl_b32 s10, s10, 12
    s_add_u32 s10, s10, 11534336
    s_xor_b32 s11, s10, 65536
    s_add_u32 s93, s10, 4194304
    s_add_u32 s94, s11, 4194304
    v_lshlrev_b32 v8, 3, v1
    v_and_b32 v31, 7, v1
    v_mul_u32_u24 v31, 1792, v31
    v_bfe_u32 v23, v1, 3, 2
    v_mul_u32_u24 v23, 114688, v23
    v_add_u32 v31, v31, v23
    v_add_u32 v31, 1788, v31
    v_and_b32 v21, 7, v1
    v_mul_u32_u24 v21, 1792, v21
    v_add_u32 v21, 1788, v21
    v_and_b32 v16, 15, v1
    v_min_u32 v16, 13, v16
    v_mul_u32_u24 v16, s87, v16
    v_bfe_u32 v23, v1, 4, 1
    v_mul_u32_u24 v23, 200704, v23
    v_add_u32 v16, v16, v23
    v_add_u32 v16, 892, v16
    s_lshl1_add_u32 s56, s85, s97
    s_lshl_b32 s54, s56, 6
    s_add_u32 s54, s54, s86
    s_lshl2_add_u32 s54, s54, s48
    s_mul_i32 s23, s54, 896
    s_add_u32 s23, s23, 7602176
    s_mov_b32 s98, 0xbdd2d3e8
    v_mov_b32 v30, 0xc0135761
    v_mov_b32 v247, s52
    v_mov_b32 v249, s52
    s_lshl2_add_u32 s99, s2, s48
    s_lshl_b32 s99, s99, 7
    s_add_u32 s99, s99, 262144
    s_lshr_b32 s53, s86, 1
    s_and_b32 s54, s53, 3
    s_lshl_b32 s54, s54, 6
    s_lshr_b32 s53, s53, 2
    s_add_u32 s53, s53, s54
    s_and_b32 s54, s86, 1
    s_lshl2_add_u32 s53, s54, s53
    s_lshr_b32 s54, s48, 1
    s_lshr_b32 s57, s56, 1
    s_lshl2_add_u32 s54, s54, s57
    s_lshl3_add_u32 s53, s54, s53
    s_lshl_b32 s53, s53, 1
    s_and_b32 s57, s56, 1
    s_add_u32 s53, s53, s57
    s_lshl_b32 s53, s53, 8
    s_add_u32 s87, s53, 262144
    v_and_b32 v20, 1, v1
    v_lshlrev_b32 v20, 7, v20
    v_lshrrev_b32 v23, 5, v1
    v_lshlrev_b32 v23, 2, v23
    s_lshl_b32 s54, s48, 4
    v_add_u32 v23, s54, v23
    v_mul_u32_u24 v23, 112, v23
    v_lshl_add_u32 v15, v2, 1, v23
    v_mov_b32 v23, 8192
    v_cmp_lt_u32 vcc, 27, v2
    s_nop 1
    v_cndmask_b32 v15, v15, v23, vcc
    v_add_u32 v23, 0, v1
    v_mul_u32_u24 v25, 147, v23
    v_lshrrev_b32 v25, 10, v25
    v_mul_u32_u24 v25, 784, v25
    v_lshl_add_u32 v236, v23, 4, v25
    v_add_u32 v23, 64, v1
    v_mul_u32_u24 v25, 147, v23
    v_lshrrev_b32 v25, 10, v25
    v_mul_u32_u24 v25, 784, v25
    v_lshl_add_u32 v237, v23, 4, v25
    v_mov_b32 v23, 2147483648
    v_cmp_lt_u32 vcc, 47, v1
    s_nop 1
    v_cndmask_b32 v237, v237, v23, vcc
    s_lshl2_add_u32 s54, s86, s48
    s_mul_i32 s44, s54, 14336
    s_mul_i32 s54, s56, 112
    s_add_u32 s44, s44, s54
    s_mul_i32 s54, s48, 1792
    v_add_u32 v238, s54, v3
    s_cmp_ge_u32 s82, 28
    s_cbranch_scc1 idle_37
poll_40:
    buffer_load_dword v23, v21, s[16:19], s4 offen sc1
    s_waitcnt vmcnt(0)
    v_cmp_eq_u32 vcc, -1, v23
    s_nop 0
    s_cbranch_vccz pdone_41
    s_add_u32 s78, s78, 1
    s_cmp_lt_u32 s78, 0x8000
    s_cbranch_scc1 poll_40
pdone_41:
    buffer_load_dword v27, v31, s[16:19], s55 offen sc1
    s_add_u32 s53, s68, s4
    buffer_load_dwordx4 v[32:35], v4, s[16:19], s53 offen offset:0 sc1
    buffer_load_dwordx4 v[36:39], v4, s[16:19], s53 offen offset:896 sc1
    buffer_load_dwordx4 v[40:43], v4, s[16:19], s53 offen offset:1792 sc1
    buffer_load_dwordx4 v[44:47], v4, s[16:19], s53 offen offset:2688 sc1
    s_add_u32 s53, s69, s4
    buffer_load_dwordx4 v[48:51], v4, s[16:19], s53 offen offset:0 sc1
    buffer_load_dwordx4 v[52:55], v4, s[16:19], s53 offen offset:896 sc1
    buffer_load_dwordx4 v[56:59], v4, s[16:19], s53 offen offset:1792 sc1
    buffer_load_dwordx4 v[60:63], v4, s[16:19], s53 offen offset:2688 sc1
    s_add_u32 s53, s70, s4
    buffer_load_dwordx4 v[64:67], v4, s[16:19], s53 offen offset:0 sc1
    buffer_load_dwordx4 v[68:71], v4, s[16:19], s53 offen offset:896 sc1
    buffer_load_dwordx4 v[72:75], v4, s[16:19], s53 offen offset:1792 sc1
    buffer_load_dwordx4 v[76:79], v4, s[16:19], s53 offen offset:2688 sc1
    s_add_u32 s53, s45, s4
    buffer_load_dwordx4 v[80:83], v4, s[16:19], s53 offen offset:0 sc1
    buffer_load_dwordx4 v[84:87], v4, s[16:19], s53 offen offset:896 sc1
    buffer_load_dwordx4 v[88:91], v4, s[16:19], s53 offen offset:1792 sc1
    buffer_load_dwordx4 v[92:95], v4, s[16:19], s53 offen offset:2688 sc1
    ds_read_b64_tr_b16 a[16:17], v234 offset:24576
    ds_read_b64_tr_b16 a[18:19], v234 offset:25600
    ds_read_b64_tr_b16 a[20:21], v235 offset:24576
    ds_read_b64_tr_b16 a[22:23], v235 offset:25600
    ds_read_b64_tr_b16 a[24:25], v234 offset:32768
    ds_read_b64_tr_b16 a[26:27], v234 offset:33792
    ds_read_b64_tr_b16 a[28:29], v235 offset:32768
    ds_read_b64_tr_b16 a[30:31], v235 offset:33792
    ds_read_b64_tr_b16 a[32:33], v234 offset:40960
    ds_read_b64_tr_b16 a[34:35], v234 offset:41984
    ds_read_b64_tr_b16 a[36:37], v235 offset:40960
    ds_read_b64_tr_b16 a[38:39], v235 offset:41984
    ds_read_b64_tr_b16 a[40:41], v232 offset:0
    ds_read_b64_tr_b16 a[42:43], v232 offset:1024
    ds_read_b64_tr_b16 a[44:45], v233 offset:0
    ds_read_b64_tr_b16 a[46:47], v233 offset:1024
    s_waitcnt vmcnt(16)
    v_cmp_eq_u32 vcc, -1, v27
    s_nop 0
    s_cbranch_vccnz re_42
bk_43:
    s_waitcnt vmcnt(15)
    v_mfma_f32_32x32x16_bf16 v[96:111], a[112:115], v[32:35], 0
    v_mfma_f32_32x32x16_bf16 v[112:127], a[116:119], v[32:35], 0
    s_add_u32 s53, s68, s5
    buffer_load_dwordx4 v[32:35], v4, s[16:19], s53 offen offset:0 sc1
    s_waitcnt vmcnt(15)
    v_mfma_f32_32x32x16_bf16 v[96:111], a[120:123], v[36:39], v[96:111]
    v_mfma_f32_32x32x16_bf16 v[112:127], a[124:127], v[36:39], v[112:127]
    buffer_load_dwordx4 v[36:39], v4, s[16:19], s53 offen offset:896 sc1
    s_waitcnt vmcnt(15)
    v_mfma_f32_32x32x16_bf16 v[96:111], a[128:131], v[40:43], v[96:111]
    v_mfma_f32_32x32x16_bf16 v[112:127], a[132:135], v[40:43], v[112:127]
    buffer_load_dwordx4 v[40:43], v4, s[16:19], s53 offen offset:1792 sc1
    s_waitcnt vmcnt(15)
    v_mfma_f32_32x32x16_bf16 v[96:111], a[136:139], v[44:47], v[96:111]
    v_mfma_f32_32x32x16_bf16 v[112:127], a[140:143], v[44:47], v[112:127]
    buffer_load_dwordx4 v[44:47], v4, s[16:19], s53 offen offset:2688 sc1
    s_waitcnt vmcnt(15)
    v_mfma_f32_32x32x16_bf16 v[96:111], a[144:147], v[48:51], v[96:111]
    v_mfma_f32_32x32x16_bf16 v[112:127], a[148:151], v[48:51], v[112:127]
    s_add_u32 s53, s69, s5
    buffer_load_dwordx4 v[48:51], v4, s[16:19], s53 offen offset:0 sc1
    s_waitcnt vmcnt(15)
    v_mfma_f32_32x32x16_bf16 v[96:111], a[152:155], v[52:55], v[96:111]
    v_mfma_f32_32x32x16_bf16 v[112:127], a[156:159], v[52:55], v[112:127]
    buffer_load_dwordx4 v[52:55], v4, s[16:19], s53 offen offset:896 sc1
    s_waitcnt vmcnt(15)
    v_mfma_f32_32x32x16_bf16 v[96:111], a[160:163], v[56:59], v[96:111]
    v_mfma_f32_32x32x16_bf16 v[112:127], a[164:167], v[56:59], v[112:127]
    buffer_load_dwordx4 v[56:59], v4, s[16:19], s53 offen offset:1792 sc1
    s_waitcnt vmcnt(15)
    v_mfma_f32_32x32x16_bf16 v[96:111], a[168:171], v[60:63], v[96:111]
    v_mfma_f32_32x32x16_bf16 v[112:127], a[172:175], v[60:63], v[112:127]
    buffer_load_dwordx4 v[60:63], v4, s[16:19], s53 offen offset:2688 sc1
    s_waitcnt vmcnt(15)
    v_mfma_f32_32x32x16_bf16 v[96:111], a[176:179], v[64:67], v[96:111]
    v_mfma_f32_32x32x16_bf16 v[112:127], a[180:183], v[64:67], v[112:127]
    s_add_u32 s53, s70, s5
    buffer_load_dwordx4 v[64:67], v4, s[16:19], s53 offen offset:0 sc1
    s_waitcnt vmcnt(15)
    v_mfma_f32_32x32x16_bf16 v[96:111], a[184:187], v[68:71], v[96:111]
    v_mfma_f32_32x32x16_bf16 v[112:127], a[188:191], v[68:71], v[112:127]
    buffer_load_dwordx4 v[68:71], v4, s[16:19], s53 offen offset:896 sc1
    s_waitcnt vmcnt(15)
    v_mfma_f32_32x32x16_bf16 v[96:111], a[192:195], v[72:75], v[96:111]
    v_mfma_f32_32x32x16_bf16 v[112:127], a[196:199], v[72:75], v[112:127]
    buffer_load_dwordx4 v[72:75], v4, s[16:19], s53 offen offset:1792 sc1
    s_waitcnt vmcnt(15)
    v_mfma_f32_32x32x16_bf16 v[96:111], a[200:203], v[76:79], v[96:111]
    v_mfma_f32_32x32x16_bf16 v[112:127], a[204:207], v[76:79], v[112:127]
    buffer_load_dwordx4 v[76:79], v4, s[16:19], s53 offen offset:2688 sc1
    s_waitcnt vmcnt(15)
    v_mfma_f32_32x32x16_bf16 v[96:111], a[208:211], v[80:83], v[96:111]
    v_mfma_f32_32x32x16_bf16 v[112:127], a[212:215], v[80:83], v[112:127]
    s_add_u32 s53, s45, s5
    buffer_load_dwordx4 v[80:83], v4, s[16:19], s53 offen offset:0 sc1
    s_waitcnt vmcnt(15)
    v_mfma_f32_32x32x16_bf16 v[96:111], a[216:219], v[84:87], v[96:111]
    v_mfma_f32_32x32x16_bf16 v[112:127], a[220:223], v[84:87], v[112:127]
    buffer_load_dwordx4 v[84:87], v4, s[16:19], s53 offen offset:896 sc1
    s_waitcnt vmcnt(15)
    v_mfma_f32_32x32x16_bf16 v[96:111], a[224:227], v[88:91], v[96:111]
    v_mfma_f32_32x32x16_bf16 v[112:127], a[228:231], v[88:91], v[112:127]
    buffer_load_dwordx4 v[88:91], v4, s[16:19], s53 offen offset:1792 sc1
    s_waitcnt vmcnt(15)
    v_mfma_f32_32x32x16_bf16 v[96:111], a[232:235], v[92:95], v[96:111]
    v_mfma_f32_32x32x16_bf16 v[112:127], a[236:239], v[92:95], v[112:127]
    buffer_load_dwordx4 v[92:95], v4, s[16:19], s53 offen offset:2688 sc1
    s_waitcnt vmcnt(15)
    v_mfma_f32_32x32x16_bf16 v[128:143], a[112:115], v[32:35], 0
    v_mfma_f32_32x32x16_bf16 v[144:159], a[116:119], v[32:35], 0
    s_nop 6
    v_cmp_u_f32 vcc, v96, v96
    s_nop 0
    s_cbranch_vccnz redo_44
back_45:
    s_add_u32 s53, s68, s6
    buffer_load_dwordx4 v[32:35], v4, s[16:19], s53 offen offset:0 sc1
    s_waitcnt vmcnt(15)
    v_mfma_f32_32x32x16_bf16 v[128:143], a[120:123], v[36:39], v[128:143]
    ds_write_b128 v17, v[104:107] offset:0
    v_mfma_f32_32x32x16_bf16 v[144:159], a[124:127], v[36:39], v[144:159]
    ds_write_b128 v17, v[108:111] offset:1024
    buffer_load_dwordx4 v[36:39], v4, s[16:19], s53 offen offset:896 sc1
    s_waitcnt vmcnt(15)
    v_mfma_f32_32x32x16_bf16 v[128:143], a[128:131], v[40:43], v[128:143]
    ds_write_b128 v18, v[112:115] offset:0
    v_mfma_f32_32x32x16_bf16 v[144:159], a[132:135], v[40:43], v[144:159]
    ds_write_b128 v18, v[116:119] offset:1024
    buffer_load_dwordx4 v[40:43], v4, s[16:19], s53 offen offset:1792 sc1
    s_waitcnt vmcnt(15)
    v_mfma_f32_32x32x16_bf16 v[128:143], a[136:139], v[44:47], v[128:143]
    ds_write_b128 v19, v[120:123] offset:0
    v_mfma_f32_32x32x16_bf16 v[144:159], a[140:143], v[44:47], v[144:159]
    ds_write_b128 v19, v[124:127] offset:1024
    buffer_load_dwordx4 v[44:47], v4, s[16:19], s53 offen offset:2688 sc1
    s_waitcnt vmcnt(15)
    v_mfma_f32_32x32x16_bf16 v[128:143], a[144:147], v[48:51], v[128:143]
    v_add_f32 v160, v96, v192
    v_add_f32 v161, v97, v193
    v_add_f32 v162, v98, v194
    v_add_f32 v163, v99, v195
    v_add_f32 v164, v100, v196
    v_add_f32 v165, v101, v197
    v_add_f32 v166, v102, v198
    v_add_f32 v167, v103, v199
    v_mfma_f32_32x32x16_bf16 v[144:159], a[148:151], v[48:51], v[144:159]
    s_waitcnt lgkmcnt(0)
    s_barrier
    ds_read_b128 v[168:171], v14 offset:0
    s_add_u32 s53, s69, s6
    buffer_load_dwordx4 v[48:51], v4, s[16:19], s53 offen offset:0 sc1
    s_waitcnt vmcnt(15)
    v_mfma_f32_32x32x16_bf16 v[128:143], a[152:155], v[52:55], v[128:143]
    ds_read_b128 v[172:175], v14 offset:1024
    ds_read_b128 v[176:179], v14 offset:2048
    ds_read_b128 v[180:183], v14 offset:3072
    ds_read_b128 v[184:187], v14 offset:4096
    ds_read_b128 v[188:191], v14 offset:5120
    v_mfma_f32_32x32x16_bf16 v[144:159], a[156:159], v[52:55], v[144:159]
    s_waitcnt lgkmcnt(4)
    v_add_f32 v160, v160, v168
    v_add_f32 v161, v161, v169
    v_add_f32 v162, v162, v170
    buffer_load_dwordx4 v[52:55], v4, s[16:19], s53 offen offset:896 sc1
    s_waitcnt vmcnt(15)
    v_mfma_f32_32x32x16_bf16 v[128:143], a[160:163], v[56:59], v[128:143]
    v_add_f32 v163, v163, v171
    v_add_f32 v164, v164, v172
    v_add_f32 v165, v165, v173
    v_add_f32 v166, v166, v174
    v_add_f32 v167, v167, v175
    s_waitcnt lgkmcnt(2)
    v_add_f32 v160, v160, v176
    v_add_f32 v161, v161, v177
    v_mfma_f32_32x32x16_bf16 v[144:159], a[164:167], v[56:59], v[144:159]
    v_add_f32 v162, v162, v178
    v_add_f32 v163, v163, v179
    v_add_f32 v164, v164, v180
    v_add_f32 v165, v165, v181
    buffer_load_dwordx4 v[56:59], v4, s[16:19], s53 offen offset:1792 sc1
    s_waitcnt vmcnt(15)
    v_mfma_f32_32x32x16_bf16 v[128:143], a[168:171], v[60:63], v[128:143]
    v_add_f32 v166, v166, v182
    v_add_f32 v167, v167, v183
    s_waitcnt lgkmcnt(0)
    v_add_f32 v160, v160, v184
    v_add_f32 v161, v161, v185
    v_add_f32 v162, v162, v186
    v_add_f32 v163, v163, v187
    v_add_f32 v164, v164, v188
    v_mfma_f32_32x32x16_bf16 v[144:159], a[172:175], v[60:63], v[144:159]
    v_add_f32 v165, v165, v189
    v_add_f32 v166, v166, v190
    v_add_f32 v167, v167, v191
    v_cvt_pk_bf16_f32 v244, v160, v161
    buffer_load_dwordx4 v[60:63], v4, s[16:19], s53 offen offset:2688 sc1
    s_waitcnt vmcnt(15)
    v_mfma_f32_32x32x16_bf16 v[128:143], a[176:179], v[64:67], v[128:143]
    v_cvt_pk_bf16_f32 v245, v162, v163
    v_cvt_pk_bf16_f32 v246, v164, v165
    v_cvt_pk_bf16_f32 v248, v166, v167
    buffer_store_dwordx4 v[244:247], v3, s[16:19], s10 offen offset:0 sc1
    buffer_store_dwordx2 v[248:249], v8, s[16:19], s10 offen offset:1024 sc1
    v_mfma_f32_32x32x16_bf16 v[144:159], a[180:183], v[64:67], v[144:159]
    s_add_u32 s53, s70, s6
    buffer_load_dwordx4 v[64:67], v4, s[16:19], s53 offen offset:0 sc1
    s_waitcnt vmcnt(17)
    v_mfma_f32_32x32x16_bf16 v[128:143], a[184:187], v[68:71], v[128:143]
    v_mfma_f32_32x32x16_bf16 v[144:159], a[188:191], v[68:71], v[144:159]
    buffer_load_dwordx4 v[68:71], v4, s[16:19], s53 offen offset:896 sc1
    s_waitcnt vmcnt(17)
    v_mfma_f32_32x32x16_bf16 v[128:143], a[192:195], v[72:75], v[128:143]
    v_mfma_f32_32x32x16_bf16 v[144:159], a[196:199], v[72:75], v[144:159]
    buffer_load_dwordx4 v[72:75], v4, s[16:19], s53 offen offset:1792 sc1
    s_waitcnt vmcnt(17)
    v_mfma_f32_32x32x16_bf16 v[128:143], a[200:203], v[76:79], v[128:143]
    v_mfma_f32_32x32x16_bf16 v[144:159], a[204:207], v[76:79], v[144:159]
    buffer_load_dwordx4 v[76:79], v4, s[16:19], s53 offen offset:2688 sc1
    s_waitcnt vmcnt(17)
    v_mfma_f32_32x32x16_bf16 v[128:143], a[208:211], v[80:83], v[128:143]
    v_mfma_f32_32x32x16_bf16 v[144:159], a[212:215], v[80:83], v[144:159]
    s_add_u32 s53, s45, s6
    buffer_load_dwordx4 v[80:83], v4, s[16:19], s53 offen offset:0 sc1
    s_waitcnt vmcnt(17)
    v_mfma_f32_32x32x16_bf16 v[128:143], a[216:219], v[84:87], v[128:143]
    v_mfma_f32_32x32x16_bf16 v[144:159], a[220:223], v[84:87], v[144:159]
    buffer_load_dwordx4 v[84:87], v4, s[16:19], s53 offen offset:896 sc1
    s_waitcnt vmcnt(17)
    v_mfma_f32_32x32x16_bf16 v[128:143], a[224:227], v[88:91], v[128:143]
    v_mfma_f32_32x32x16_bf16 v[144:159], a[228:231], v[88:91], v[144:159]
    buffer_load_dwordx4 v[88:91], v4, s[16:19], s53 offen offset:1792 sc1
    s_waitcnt vmcnt(17)
    v_mfma_f32_32x32x16_bf16 v[128:143], a[232:235], v[92:95], v[128:143]
    v_mfma_f32_32x32x16_bf16 v[144:159], a[236:239], v[92:95], v[144:159]
    buffer_load_dwordx4 v[92:95], v4, s[16:19], s53 offen offset:2688 sc1
    s_waitcnt vmcnt(17)
    v_mfma_f32_32x32x16_bf16 v[96:111], a[112:115], v[32:35], 0
    v_mfma_f32_32x32x16_bf16 v[112:127], a[116:119], v[32:35], 0
    s_nop 6
    v_cmp_u_f32 vcc, v128, v128
    s_nop 0
    s_cbranch_vccnz redo_46
back_47:
    s_add_u32 s53, s68, s7
    buffer_load_dwordx4 v[32:35], v4, s[16:19], s53 offen offset:0 sc1
    s_waitcnt vmcnt(17)
    v_mfma_f32_32x32x16_bf16 v[96:111], a[120:123], v[36:39], v[96:111]
    ds_write_b128 v17, v[136:139] offset:24576
    v_mfma_f32_32x32x16_bf16 v[112:127], a[124:127], v[36:39], v[112:127]
    ds_write_b128 v17, v[140:143] offset:25600
    buffer_load_dwordx4 v[36:39], v4, s[16:19], s53 offen offset:896 sc1
    s_waitcnt vmcnt(17)
    v_mfma_f32_32x32x16_bf16 v[96:111], a[128:131], v[40:43], v[96:111]
    ds_write_b128 v18, v[144:147] offset:24576
    v_mfma_f32_32x32x16_bf16 v[112:127], a[132:135], v[40:43], v[112:127]
    ds_write_b128 v18, v[148:151] offset:25600
    buffer_load_dwordx4 v[40:43], v4, s[16:19], s53 offen offset:1792 sc1
    s_waitcnt vmcnt(17)
    v_mfma_f32_32x32x16_bf16 v[96:111], a[136:139], v[44:47], v[96:111]
    ds_write_b128 v19, v[152:155] offset:24576
    v_mfma_f32_32x32x16_bf16 v[112:127], a[140:143], v[44:47], v[112:127]
    ds_write_b128 v19, v[156:159] offset:25600
    buffer_load_dwordx4 v[44:47], v4, s[16:19], s53 offen offset:2688 sc1
    s_waitcnt vmcnt(17)
    v_mfma_f32_32x32x16_bf16 v[96:111], a[144:147], v[48:51], v[96:111]
    v_add_f32 v160, v128, v192
    v_add_f32 v161, v129, v193
    v_add_f32 v162, v130, v194
    v_add_f32 v163, v131, v195
    v_add_f32 v164, v132, v196
    v_add_f32 v165, v133, v197
    v_add_f32 v166, v134, v198
    v_add_f32 v167, v135, v199
    v_mfma_f32_32x32x16_bf16 v[112:127], a[148:151], v[48:51], v[112:127]
    s_waitcnt lgkmcnt(0)
    s_barrier
    ds_read_b128 v[168:171], v14 offset:24576
    s_add_u32 s53, s69, s7
    buffer_load_dwordx4 v[48:51], v4, s[16:19], s53 offen offset:0 sc1
    s_waitcnt vmcnt(17)
    v_mfma_f32_32x32x16_bf16 v[96:111], a[152:155], v[52:55], v[96:111]
    ds_read_b128 v[172:175], v14 offset:25600
    ds_read_b128 v[176:179], v14 offset:26624
    ds_read_b128 v[180:183], v14 offset:27648
    ds_read_b128 v[184:187], v14 offset:28672
    ds_read_b128 v[188:191], v14 offset:29696
    v_mfma_f32_32x32x16_bf16 v[112:127], a[156:159], v[52:55], v[112:127]
    s_waitcnt lgkmcnt(4)
    v_add_f32 v160, v160, v168
    v_add_f32 v161, v161, v169
    v_add_f32 v162, v162, v170
    buffer_load_dwordx4 v[52:55], v4, s[16:19], s53 offen offset:896 sc1
    s_waitcnt vmcnt(17)
    v_mfma_f32_32x32x16_bf16 v[96:111], a[160:163], v[56:59], v[96:111]
    v_add_f32 v163, v163, v171
    v_add_f32 v164, v164, v172
    v_add_f32 v165, v165, v173
    v_add_f32 v166, v166, v174
    v_add_f32 v167, v167, v175
    s_waitcnt lgkmcnt(2)
    v_add_f32 v160, v160, v176
    v_add_f32 v161, v161, v177
    v_mfma_f32_32x32x16_bf16 v[112:127], a[164:167], v[56:59], v[112:127]
    v_add_f32 v162, v162, v178
    v_add_f32 v163, v163, v179
    v_add_f32 v164, v164, v180
    v_add_f32 v165, v165, v181
    buffer_load_dwordx4 v[56:59], v4, s[16:19], s53 offen offset:1792 sc1
    s_waitcnt vmcnt(17)
    v_mfma_f32_32x32x16_bf16 v[96:111], a[168:171], v[60:63], v[96:111]
    v_add_f32 v166, v166, v182
    v_add_f32 v167, v167, v183
    s_waitcnt lgkmcnt(0)
    v_add_f32 v160, v160, v184
    v_add_f32 v161, v161, v185
    v_add_f32 v162, v162, v186
    v_add_f32 v163, v163, v187
    v_add_f32 v164, v164, v188
    v_mfma_f32_32x32x16_bf16 v[112:127], a[172:175], v[60:63], v[112:127]
    v_add_f32 v165, v165, v189
    v_add_f32 v166, v166, v190
    v_add_f32 v167, v167, v191
    v_cvt_pk_bf16_f32 v244, v160, v161
    buffer_load_dwordx4 v[60:63], v4, s[16:19], s53 offen offset:2688 sc1
    s_waitcnt vmcnt(15)
    v_mfma_f32_32x32x16_bf16 v[96:111], a[176:179], v[64:67], v[96:111]
    v_cvt_pk_bf16_f32 v245, v162, v163
    v_cvt_pk_bf16_f32 v246, v164, v165
    v_cvt_pk_bf16_f32 v248, v166, v167
    buffer_store_dwordx4 v[244:247], v3, s[16:19], s10 offen offset:2048 sc1
    buffer_store_dwordx2 v[248:249], v8, s[16:19], s10 offen offset:3072 sc1
    v_mfma_f32_32x32x16_bf16 v[112:127], a[180:183], v[64:67], v[112:127]
    s_add_u32 s53, s70, s7
    buffer_load_dwordx4 v[64:67], v4, s[16:19], s53 offen offset:0 sc1
    s_waitcnt vmcnt(17)
    v_mfma_f32_32x32x16_bf16 v[96:111], a[184:187], v[68:71], v[96:111]
    v_mfma_f32_32x32x16_bf16 v[112:127], a[188:191], v[68:71], v[112:127]
    buffer_load_dwordx4 v[68:71], v4, s[16:19], s53 offen offset:896 sc1
    s_waitcnt vmcnt(17)
    v_mfma_f32_32x32x16_bf16 v[96:111], a[192:195], v[72:75], v[96:111]
    v_mfma_f32_32x32x16_bf16 v[112:127], a[196:199], v[72:75], v[112:127]
    buffer_load_dwordx4 v[72:75], v4, s[16:19], s53 offen offset:1792 sc1
    s_waitcnt vmcnt(17)
    v_mfma_f32_32x32x16_bf16 v[96:111], a[200:203], v[76:79], v[96:111]
    v_mfma_f32_32x32x16_bf16 v[112:127], a[204:207], v[76:79], v[112:127]
    buffer_load_dwordx4 v[76:79], v4, s[16:19], s53 offen offset:2688 sc1
    s_waitcnt vmcnt(17)
    v_mfma_f32_32x32x16_bf16 v[96:111], a[208:211], v[80:83], v[96:111]
    v_mfma_f32_32x32x16_bf16 v[112:127], a[212:215], v[80:83], v[112:127]
    s_add_u32 s53, s45, s7
    buffer_load_dwordx4 v[80:83], v4, s[16:19], s53 offen offset:0 sc1
    s_waitcnt vmcnt(17)
    v_mfma_f32_32x32x16_bf16 v[96:111], a[216:219], v[84:87], v[96:111]
    v_mfma_f32_32x32x16_bf16 v[112:127], a[220:223], v[84:87], v[112:127]
    buffer_load_dwordx4 v[84:87], v4, s[16:19], s53 offen offset:896 sc1
    s_waitcnt vmcnt(17)
    v_mfma_f32_32x32x16_bf16 v[96:111], a[224:227], v[88:91], v[96:111]
    v_mfma_f32_32x32x16_bf16 v[112:127], a[228:231], v[88:91], v[112:127]
    buffer_load_dwordx4 v[88:91], v4, s[16:19], s53 offen offset:1792 sc1
    s_waitcnt vmcnt(17)
    v_mfma_f32_32x32x16_bf16 v[96:111], a[232:235], v[92:95], v[96:111]
    v_mfma_f32_32x32x16_bf16 v[112:127], a[236:239], v[92:95], v[112:127]
    buffer_load_dwordx4 v[92:95], v4, s[16:19], s53 offen offset:2688 sc1
    s_waitcnt vmcnt(17)
    v_mfma_f32_32x32x16_bf16 v[128:143], a[112:115], v[32:35], 0
    v_mfma_f32_32x32x16_bf16 v[144:159], a[116:119], v[32:35], 0
    buffer_load_dwordx4 v[216:219], v3, s[16:19], s11 offen offset:0 sc1
    buffer_load_dwordx2 v[220:221], v8, s[16:19], s11 offen offset:1024 sc1
    s_waitcnt vmcnt(18)
    v_mfma_f32_32x32x16_bf16 v[128:143], a[120:123], v[36:39], v[128:143]
    s_nop 2
    v_cmp_u_f32 vcc, v96, v96
    s_nop 0
    s_cbranch_vccnz redo_48
back_49:
    ds_write_b128 v17, v[104:107] offset:0
    v_mfma_f32_32x32x16_bf16 v[144:159], a[124:127], v[36:39], v[144:159]
    ds_write_b128 v17, v[108:111] offset:1024
    s_waitcnt vmcnt(17)
    v_mfma_f32_32x32x16_bf16 v[128:143], a[128:131], v[40:43], v[128:143]
    ds_write_b128 v18, v[112:115] offset:0
    v_mfma_f32_32x32x16_bf16 v[144:159], a[132:135], v[40:43], v[144:159]
    buffer_store_dwordx4 v[208:211], v4, s[16:19], s79 offen sc1
    s_waitcnt vmcnt(17)
    v_mfma_f32_32x32x16_bf16 v[128:143], a[136:139], v[44:47], v[128:143]
    ds_write_b128 v18, v[116:119] offset:1024
    v_mfma_f32_32x32x16_bf16 v[144:159], a[140:143], v[44:47], v[144:159]
    buffer_store_dwordx4 v[212:215], v4, s[16:19], s79 offen offset:896 sc1
    s_waitcnt vmcnt(17)
    v_mfma_f32_32x32x16_bf16 v[128:143], a[144:147], v[48:51], v[128:143]
    ds_write_b128 v19, v[120:123] offset:0
    v_mfma_f32_32x32x16_bf16 v[144:159], a[148:151], v[48:51], v[144:159]
    s_add_u32 m0, s90, 0
    s_nop 0
    buffer_load_dwordx4 v11, s[28:31], s74 offen lds
    buffer_load_dwordx4 v12, s[28:31], s74 offen offset:1024 lds
    s_waitcnt vmcnt(18)
    v_mfma_f32_32x32x16_bf16 v[128:143], a[152:155], v[52:55], v[128:143]
    ds_write_b128 v19, v[124:127] offset:1024
    v_mfma_f32_32x32x16_bf16 v[144:159], a[156:159], v[52:55], v[144:159]
    s_waitcnt vmcnt(17)
    v_mfma_f32_32x32x16_bf16 v[128:143], a[160:163], v[56:59], v[128:143]
    s_add_u32 m0, s90, 8192
    s_add_u32 s88, s74, 65536
    buffer_load_dwordx4 v11, s[28:31], s88 offen lds
    buffer_load_dwordx4 v12, s[28:31], s88 offen offset:1024 lds
    v_mfma_f32_32x32x16_bf16 v[144:159], a[164:167], v[56:59], v[144:159]
    s_waitcnt lgkmcnt(0)
    s_barrier
    ds_read_b128 v[168:171], v14 offset:0
    ds_read_b128 v[172:175], v14 offset:1024
    ds_read_b128 v[176:179], v14 offset:2048
    s_waitcnt vmcnt(18)
    v_mfma_f32_32x32x16_bf16 v[128:143], a[168:171], v[60:63], v[128:143]
    ds_read_b128 v[180:183], v14 offset:3072
    ds_read_b128 v[184:187], v14 offset:4096
    ds_read_b128 v[188:191], v14 offset:5120
    v_mfma_f32_32x32x16_bf16 v[144:159], a[172:175], v[60:63], v[144:159]
    s_waitcnt lgkmcnt(4)
    v_add_f32 v160, v96, v168
    v_add_f32 v161, v97, v169
    v_add_f32 v162, v98, v170
    v_add_f32 v163, v99, v171
    s_waitcnt vmcnt(15)
    v_mfma_f32_32x32x16_bf16 v[128:143], a[176:179], v[64:67], v[128:143]
    v_add_f32 v164, v100, v172
    v_add_f32 v165, v101, v173
    v_add_f32 v166, v102, v174
    v_add_f32 v167, v103, v175
    s_waitcnt lgkmcnt(2)
    v_add_f32 v160, v160, v176
    v_mfma_f32_32x32x16_bf16 v[144:159], a[180:183], v[64:67], v[144:159]
    v_add_f32 v161, v161, v177
    v_add_f32 v162, v162, v178
    v_add_f32 v163, v163, v179
    v_add_f32 v164, v164, v180
    v_add_f32 v165, v165, v181
    s_waitcnt vmcnt(14)
    v_mfma_f32_32x32x16_bf16 v[128:143], a[184:187], v[68:71], v[128:143]
    v_add_f32 v166, v166, v182
    v_add_f32 v167, v167, v183
    s_waitcnt lgkmcnt(0)
    v_add_f32 v160, v160, v184
    v_add_f32 v161, v161, v185
    v_add_f32 v162, v162, v186
    v_mfma_f32_32x32x16_bf16 v[144:159], a[188:191], v[68:71], v[144:159]
    v_add_f32 v163, v163, v187
    v_add_f32 v164, v164, v188
    v_add_f32 v165, v165, v189
    v_add_f32 v166, v166, v190
    v_add_f32 v167, v167, v191
    s_waitcnt vmcnt(13)
    v_mfma_f32_32x32x16_bf16 v[128:143], a[192:195], v[72:75], v[128:143]
    s_waitcnt vmcnt(6)
    v_xor_b32 v219, s52, v219
    v_xor_b32 v221, s52, v221
    v_or_b32 v221, v219, v221
    v_mov_b32 v219, v220
    v_cmp_ne_u32 vcc, 0, v221
    s_nop 0
    s_cbranch_vccnz xre_50
xback_51:
    v_mfma_f32_32x32x16_bf16 v[160:175], v[240:243], v[216:219], v[160:175]
    v_mfma_f32_32x32x16_bf16 v[144:159], a[196:199], v[72:75], v[144:159]
    v_mfma_f32_32x32x16_bf16 v[128:143], a[200:203], v[76:79], v[128:143]
    s_nop 9
    v_mul_f32 v168, v160, v160
    v_mul_f32 v169, v161, v161
    v_mul_f32 v170, v162, v162
    v_mul_f32 v171, v163, v163
    v_mul_f32 v172, v164, v164
    v_mul_f32 v173, v165, v165
    v_mfma_f32_32x32x16_bf16 v[144:159], a[204:207], v[76:79], v[144:159]
    buffer_load_dwordx4 v[224:227], v3, s[16:19], s11 offen offset:2048 sc1
    buffer_load_dwordx2 v[228:229], v8, s[16:19], s11 offen offset:3072 sc1
    v_mfma_f32_32x32x16_bf16 v[128:143], a[208:211], v[80:83], v[128:143]
    v_mul_f32 v174, v166, v166
    v_mul_f32 v175, v167, v167
    v_fma_f32 v168, v168, s98, v30
    v_fma_f32 v169, v169, s98, v30
    v_fma_f32 v170, v170, s98, v30
    v_mfma_f32_32x32x16_bf16 v[144:159], a[212:215], v[80:83], v[144:159]
    v_fma_f32 v171, v171, s98, v30
    v_fma_f32 v172, v172, s98, v30
    v_fma_f32 v173, v173, s98, v30
    v_fma_f32 v174, v174, s98, v30
    v_mfma_f32_32x32x16_bf16 v[128:143], a[216:219], v[84:87], v[128:143]
    v_fma_f32 v175, v175, s98, v30
    v_mul_f32 v168, v168, v160
    v_mul_f32 v169, v169, v161
    v_mul_f32 v170, v170, v162
    v_mul_f32 v171, v171, v163
    v_mul_f32 v172, v172, v164
    v_mfma_f32_32x32x16_bf16 v[144:159], a[220:223], v[84:87], v[144:159]
    v_mul_f32 v173, v173, v165
    v_mul_f32 v174, v174, v166
    v_mul_f32 v175, v175, v167
    v_exp_f32 v168, v168
    v_mfma_f32_32x32x16_bf16 v[128:143], a[224:227], v[88:91], v[128:143]
    v_exp_f32 v169, v169
    v_exp_f32 v170, v170
    v_exp_f32 v171, v171
    v_mfma_f32_32x32x16_bf16 v[144:159], a[228:231], v[88:91], v[144:159]
    v_exp_f32 v172, v172
    v_exp_f32 v173, v173
    v_exp_f32 v174, v174
    v_mfma_f32_32x32x16_bf16 v[128:143], a[232:235], v[92:95], v[128:143]
    v_exp_f32 v175, v175
    v_add_f32 v168, 1.0, v168
    v_add_f32 v169, 1.0, v169
    v_add_f32 v170, 1.0, v170
    v_add_f32 v171, 1.0, v171
    v_mfma_f32_32x32x16_bf16 v[144:159], a[236:239], v[92:95], v[144:159]
    v_add_f32 v172, 1.0, v172
    v_add_f32 v173, 1.0, v173
    v_add_f32 v174, 1.0, v174
    v_add_f32 v175, 1.0, v175
    v_rcp_f32 v168, v168
    v_rcp_f32 v169, v169
    v_rcp_f32 v170, v170
    v_rcp_f32 v171, v171
    v_rcp_f32 v172, v172
    v_rcp_f32 v173, v173
    v_cmp_u_f32 vcc, v128, v128
    s_nop 0
    s_cbranch_vccnz redo_52
back_53:
    ds_write_b128 v17, v[136:139] offset:24576
    v_rcp_f32 v174, v174
    v_rcp_f32 v175, v175
    v_pk_mul_f32 v[168:169], v[168:169], v[160:161]
    v_pk_mul_f32 v[170:171], v[170:171], v[162:163]
    ds_write_b128 v17, v[140:143] offset:25600
    v_pk_mul_f32 v[172:173], v[172:173], v[164:165]
    v_pk_mul_f32 v[174:175], v[174:175], v[166:167]
    v_cvt_pk_bf16_f32 v176, v168, v169
    v_cvt_pk_bf16_f32 v177, v170, v171
    v_cvt_pk_bf16_f32 v178, v172, v173
    ds_write_b128 v18, v[144:147] offset:24576
    v_cvt_pk_bf16_f32 v179, v174, v175
    buffer_store_dwordx4 v[176:179], v4, s[16:19], s96 offen sc1
    s_add_u32 s96, s96, 100352
    ds_write_b128 v18, v[148:151] offset:25600
    ds_write_b128 v19, v[152:155] offset:24576
    ds_write_b128 v19, v[156:159] offset:25600
    s_waitcnt lgkmcnt(0)
    s_barrier
    ds_read_b128 v[104:107], v14 offset:24576
    ds_read_b128 v[108:111], v14 offset:25600
    ds_read_b128 v[112:115], v14 offset:26624
    ds_read_b128 v[116:119], v14 offset:27648
    ds_read_b128 v[120:123], v14 offset:28672
    ds_read_b128 v[124:127], v14 offset:29696
    s_waitcnt vmcnt(1)
    v_xor_b32 v227, s52, v227
    v_xor_b32 v229, s52, v229
    v_or_b32 v229, v227, v229
    v_mov_b32 v227, v228
    v_cmp_ne_u32 vcc, 0, v229
    s_nop 0
    s_cbranch_vccnz xre_54
xback_55:
    v_mfma_f32_32x32x16_bf16 v[128:143], v[240:243], v[224:227], v[128:143]
    s_waitcnt lgkmcnt(4)
    s_nop 10
    v_pk_add_f32 v[96:97], v[128:129], v[104:105]
    v_pk_add_f32 v[98:99], v[130:131], v[106:107]
    v_pk_add_f32 v[100:101], v[132:133], v[108:109]
    v_pk_add_f32 v[102:103], v[134:135], v[110:111]
    s_waitcnt lgkmcnt(2)
    v_pk_add_f32 v[96:97], v[96:97], v[112:113]
    v_pk_add_f32 v[98:99], v[98:99], v[114:115]
    v_pk_add_f32 v[100:101], v[100:101], v[116:117]
    v_pk_add_f32 v[102:103], v[102:103], v[118:119]
    s_waitcnt lgkmcnt(0)
    v_pk_add_f32 v[96:97], v[96:97], v[120:121]
    v_pk_add_f32 v[98:99], v[98:99], v[122:123]
    v_pk_add_f32 v[100:101], v[100:101], v[124:125]
    v_pk_add_f32 v[102:103], v[102:103], v[126:127]
    v_pk_mul_f32 v[104:105], v[96:97], v[96:97]
    v_pk_mul_f32 v[106:107], v[98:99], v[98:99]
    v_pk_mul_f32 v[108:109], v[100:101], v[100:101]
    v_pk_mul_f32 v[110:111], v[102:103], v[102:103]
    v_pk_fma_f32 v[104:105], v[104:105], s[98:99], v[30:31] op_sel_hi:[1,0,0]
    v_pk_fma_f32 v[106:107], v[106:107], s[98:99], v[30:31] op_sel_hi:[1,0,0]
    v_pk_fma_f32 v[108:109], v[108:109], s[98:99], v[30:31] op_sel_hi:[1,0,0]
    v_pk_fma_f32 v[110:111], v[110:111], s[98:99], v[30:31] op_sel_hi:[1,0,0]
    v_pk_mul_f32 v[104:105], v[104:105], v[96:97]
    v_pk_mul_f32 v[106:107], v[106:107], v[98:99]
    v_pk_mul_f32 v[108:109], v[108:109], v[100:101]
    v_pk_mul_f32 v[110:111], v[110:111], v[102:103]
    v_exp_f32 v104, v104
    v_exp_f32 v105, v105
    v_exp_f32 v106, v106
    v_exp_f32 v107, v107
    v_exp_f32 v108, v108
    v_exp_f32 v109, v109
    v_exp_f32 v110, v110
    v_exp_f32 v111, v111
    v_pk_add_f32 v[104:105], v[104:105], 1.0 op_sel_hi:[1,0]
    v_pk_add_f32 v[106:107], v[106:107], 1.0 op_sel_hi:[1,0]
    v_pk_add_f32 v[108:109], v[108:109], 1.0 op_sel_hi:[1,0]
    v_pk_add_f32 v[110:111], v[110:111], 1.0 op_sel_hi:[1,0]
    v_rcp_f32 v104, v104
    v_rcp_f32 v105, v105
    v_rcp_f32 v106, v106
    v_rcp_f32 v107, v107
    v_rcp_f32 v108, v108
    v_rcp_f32 v109, v109
    v_rcp_f32 v110, v110
    v_rcp_f32 v111, v111
    v_pk_mul_f32 v[104:105], v[104:105], v[96:97]
    v_pk_mul_f32 v[106:107], v[106:107], v[98:99]
    v_pk_mul_f32 v[108:109], v[108:109], v[100:101]
    v_pk_mul_f32 v[110:111], v[110:111], v[102:103]
    v_cvt_pk_bf16_f32 v112, v104, v105
    v_cvt_pk_bf16_f32 v113, v106, v107
    v_cvt_pk_bf16_f32 v114, v108, v109
    v_cvt_pk_bf16_f32 v115, v110, v111
    buffer_store_dwordx4 v[112:115], v4, s[16:19], s96 offen sc1
    buffer_store_dword v247, v0, s[16:19], s99 offen sc1
    s_add_u32 m0, s90, 16384
    s_nop 0
    buffer_load_dwordx4 v11, s[28:31], s75 offen lds
    buffer_load_dwordx4 v12, s[28:31], s75 offen offset:1024 lds
    s_add_u32 m0, s90, 24576
    s_add_u32 s88, s75, 65536
    buffer_load_dwordx4 v11, s[28:31], s88 offen lds
    buffer_load_dwordx4 v12, s[28:31], s88 offen offset:1024 lds
    s_add_u32 m0, s90, 32768
    s_nop 0
    buffer_load_dwordx4 v11, s[28:31], s76 offen lds
    buffer_load_dwordx4 v12, s[28:31], s76 offen offset:1024 lds
    s_add_u32 m0, s90, 40960
    s_add_u32 s88, s76, 65536
    buffer_load_dwordx4 v11, s[28:31], s88 offen lds
    buffer_load_dwordx4 v12, s[28:31], s88 offen offset:1024 lds
    s_add_u32 m0, s90, 49152
    s_nop 0
    buffer_load_dwordx4 v11, s[28:31], s77 offen lds
    buffer_load_dwordx4 v12, s[28:31], s77 offen offset:1024 lds
    s_add_u32 m0, s90, 57344
    s_add_u32 s88, s77, 65536
    buffer_load_dwordx4 v11, s[28:31], s88 offen lds
    buffer_load_dwordx4 v12, s[28:31], s88 offen offset:1024 lds
join_38:
    s_add_u32 s53, s46, s8
    buffer_load_dwordx4 v[32:35], v4, s[16:19], s53 offen offset:0 sc1
    buffer_load_dwordx4 v[36:39], v4, s[16:19], s53 offen offset:896 sc1
    s_add_u32 s53, s47, s8
    buffer_load_dwordx4 v[40:43], v4, s[16:19], s53 offen offset:0 sc1
    buffer_load_dwordx4 v[44:47], v4, s[16:19], s53 offen offset:896 sc1
    s_add_u32 s53, s91, s8
    buffer_load_dwordx4 v[48:51], v4, s[16:19], s53 offen offset:0 sc1
    buffer_load_dwordx4 v[52:55], v4, s[16:19], s53 offen offset:896 sc1
    s_add_u32 s53, s92, s8
    buffer_load_dwordx4 v[56:59], v4, s[16:19], s53 offen offset:0 sc1
    buffer_load_dwordx4 v[60:63], v4, s[16:19], s53 offen offset:896 sc1
    s_add_u32 s53, s51, s8
    buffer_load_dwordx4 v[64:67], v4, s[16:19], s53 offen offset:0 sc1
    buffer_load_dwordx4 v[68:71], v4, s[16:19], s53 offen offset:896 sc1
    s_add_u32 s53, s62, s8
    buffer_load_dwordx4 v[72:75], v4, s[16:19], s53 offen offset:0 sc1
    buffer_load_dwordx4 v[76:79], v4, s[16:19], s53 offen offset:896 sc1
    s_add_u32 s53, s100, s8
    buffer_load_dwordx4 v[80:83], v4, s[16:19], s53 offen offset:0 sc1
    buffer_load_dwordx4 v[84:87], v4, s[16:19], s53 offen offset:896 sc1
    s_add_u32 s53, s46, s9
    buffer_load_dwordx4 v[88:91], v4, s[16:19], s53 offen offset:0 sc1
    buffer_load_dwordx4 v[92:95], v4, s[16:19], s53 offen offset:896 sc1
    buffer_load_dword v27, v16, s[16:19], s22 offen sc1
    buffer_load_dword v31, v20, s[16:19], s87 offen sc1
    s_waitcnt vmcnt(17)
    v_cmp_eq_u32 vcc, -1, v32
    s_nop 0
    s_cbranch_vccnz f_56e0
f_56b0:
    v_mfma_f32_32x32x16_bf16 v[96:111], a[0:3], v[32:35], 0
    s_waitcnt vmcnt(16)
    v_cmp_eq_u32 vcc, -1, v36
    v_mfma_f32_32x32x16_bf16 v[112:127], a[4:7], v[32:35], 0
    s_cbranch_vccnz f_56e1
f_56b1:
    s_add_u32 s53, s47, s9
    buffer_load_dwordx4 v[32:35], v4, s[16:19], s53 offen offset:0 sc1
    v_mfma_f32_32x32x16_bf16 v[96:111], a[8:11], v[36:39], v[96:111]
    s_waitcnt vmcnt(16)
    v_cmp_eq_u32 vcc, -1, v40
    v_mfma_f32_32x32x16_bf16 v[112:127], a[12:15], v[36:39], v[112:127]
    s_cbranch_vccnz f_56e2
f_56b2:
    buffer_load_dwordx4 v[36:39], v4, s[16:19], s53 offen offset:896 sc1
    v_mfma_f32_32x32x16_bf16 v[96:111], a[16:19], v[40:43], v[96:111]
    s_waitcnt vmcnt(16)
    v_cmp_eq_u32 vcc, -1, v44
    v_mfma_f32_32x32x16_bf16 v[112:127], a[20:23], v[40:43], v[112:127]
    s_cbranch_vccnz f_56e3
f_56b3:
    s_add_u32 s53, s91, s9
    buffer_load_dwordx4 v[40:43], v4, s[16:19], s53 offen offset:0 sc1
    v_mfma_f32_32x32x16_bf16 v[96:111], a[24:27], v[44:47], v[96:111]
    s_waitcnt vmcnt(16)
    v_cmp_eq_u32 vcc, -1, v48
    v_mfma_f32_32x32x16_bf16 v[112:127], a[28:31], v[44:47], v[112:127]
    s_cbranch_vccnz f_56e4
f_56b4:
    buffer_load_dwordx4 v[44:47], v4, s[16:19], s53 offen offset:896 sc1
    v_mfma_f32_32x32x16_bf16 v[96:111], a[32:35], v[48:51], v[96:111]
    ds_read_b64_tr_b16 a[48:49], v232 offset:0
    ds_read_b64_tr_b16 a[50:51], v232 offset:1024
    ds_read_b64_tr_b16 a[52:53], v233 offset:0
    ds_read_b64_tr_b16 a[54:55], v233 offset:1024
    s_waitcnt vmcnt(16)
    v_cmp_eq_u32 vcc, -1, v52
    v_mfma_f32_32x32x16_bf16 v[112:127], a[36:39], v[48:51], v[112:127]
    s_cbranch_vccnz f_56e5
f_56b5:
    s_add_u32 s53, s92, s9
    buffer_load_dwordx4 v[48:51], v4, s[16:19], s53 offen offset:0 sc1
    v_mfma_f32_32x32x16_bf16 v[96:111], a[40:43], v[52:55], v[96:111]
    ds_read_b64_tr_b16 a[56:57], v232 offset:8192
    ds_read_b64_tr_b16 a[58:59], v232 offset:9216
    ds_read_b64_tr_b16 a[60:61], v233 offset:8192
    ds_read_b64_tr_b16 a[62:63], v233 offset:9216
    s_waitcnt vmcnt(16)
    v_cmp_eq_u32 vcc, -1, v56
    v_mfma_f32_32x32x16_bf16 v[112:127], a[44:47], v[52:55], v[112:127]
    s_cbranch_vccnz f_56e6
f_56b6:
    s_waitcnt vmcnt(5)
    v_cmp_ne_u32 vcc, s52, v31
    s_nop 0
    s_cbranch_vccnz re_59
bk_60:
    buffer_load_dwordx4 v[208:211], v4, s[16:19], s23 offen sc1
    s_add_u32 s23, s23, 114688
    buffer_load_dwordx4 v[212:215], v4, s[16:19], s23 offen sc1
    buffer_load_dwordx4 v[52:55], v4, s[16:19], s53 offen offset:896 sc1
    s_waitcnt lgkmcnt(4)
    v_mfma_f32_32x32x16_bf16 v[96:111], a[48:51], v[56:59], v[96:111]
    ds_read_b64_tr_b16 a[64:65], v232 offset:16384
    ds_read_b64_tr_b16 a[66:67], v232 offset:17408
    ds_read_b64_tr_b16 a[68:69], v233 offset:16384
    ds_read_b64_tr_b16 a[70:71], v233 offset:17408
    v_cmp_eq_u32 vcc, -1, v60
    v_mfma_f32_32x32x16_bf16 v[112:127], a[52:55], v[56:59], v[112:127]
    s_cbranch_vccnz f_56e7
f_56b7:
    s_add_u32 s53, s51, s9
    buffer_load_dwordx4 v[56:59], v4, s[16:19], s53 offen offset:0 sc1
    s_waitcnt lgkmcnt(4)
    v_mfma_f32_32x32x16_bf16 v[96:111], a[56:59], v[60:63], v[96:111]
    ds_read_b64_tr_b16 a[72:73], v232 offset:24576
    ds_read_b64_tr_b16 a[74:75], v232 offset:25600
    ds_read_b64_tr_b16 a[76:77], v233 offset:24576
    ds_read_b64_tr_b16 a[78:79], v233 offset:25600
    v_cmp_eq_u32 vcc, -1, v64
    v_mfma_f32_32x32x16_bf16 v[112:127], a[60:63], v[60:63], v[112:127]
    s_cbranch_vccnz f_56e8
f_56b8:
    buffer_load_dwordx4 v[60:63], v4, s[16:19], s53 offen offset:896 sc1
    s_waitcnt lgkmcnt(4)
    v_mfma_f32_32x32x16_bf16 v[96:111], a[64:67], v[64:67], v[96:111]
    ds_read_b64_tr_b16 a[80:81], v232 offset:32768
    ds_read_b64_tr_b16 a[82:83], v232 offset:33792
    ds_read_b64_tr_b16 a[84:85], v233 offset:32768
    ds_read_b64_tr_b16 a[86:87], v233 offset:33792
    v_cmp_eq_u32 vcc, -1, v68
    v_mfma_f32_32x32x16_bf16 v[112:127], a[68:71], v[64:67], v[112:127]
    s_cbranch_vccnz f_56e9
f_56b9:
    s_add_u32 s53, s62, s9
    buffer_load_dwordx4 v[64:67], v4, s[16:19], s53 offen offset:0 sc1
    s_waitcnt lgkmcnt(4)
    v_mfma_f32_32x32x16_bf16 v[96:111], a[72:75], v[68:71], v[96:111]
    ds_read_b64_tr_b16 a[88:89], v232 offset:40960
    ds_read_b64_tr_b16 a[90:91], v232 offset:41984
    ds_read_b64_tr_b16 a[92:93], v233 offset:40960
    ds_read_b64_tr_b16 a[94:95], v233 offset:41984
    v_cmp_eq_u32 vcc, -1, v72
    v_mfma_f32_32x32x16_bf16 v[112:127], a[76:79], v[68:71], v[112:127]
    s_cbranch_vccnz f_56e10
f_56b10:
    buffer_load_dwordx4 v[68:71], v4, s[16:19], s53 offen offset:896 sc1
    s_waitcnt lgkmcnt(4)
    v_mfma_f32_32x32x16_bf16 v[96:111], a[80:83], v[72:75], v[96:111]
    ds_read_b64_tr_b16 a[96:97], v232 offset:49152
    ds_read_b64_tr_b16 a[98:99], v232 offset:50176
    ds_read_b64_tr_b16 a[100:101], v233 offset:49152
    ds_read_b64_tr_b16 a[102:103], v233 offset:50176
    v_cmp_eq_u32 vcc, -1, v76
    v_mfma_f32_32x32x16_bf16 v[112:127], a[84:87], v[72:75], v[112:127]
    s_cbranch_vccnz f_56e11
f_56b11:
    s_add_u32 s53, s100, s9
    buffer_load_dwordx4 v[72:75], v4, s[16:19], s53 offen offset:0 sc1
    s_waitcnt lgkmcnt(4)
    v_mfma_f32_32x32x16_bf16 v[96:111], a[88:91], v[76:79], v[96:111]
    ds_read_b64_tr_b16 a[104:105], v232 offset:57344
    ds_read_b64_tr_b16 a[106:107], v232 offset:58368
    ds_read_b64_tr_b16 a[108:109], v233 offset:57344
    ds_read_b64_tr_b16 a[110:111], v233 offset:58368
    v_cmp_eq_u32 vcc, -1, v80
    v_mfma_f32_32x32x16_bf16 v[112:127], a[92:95], v[76:79], v[112:127]
    s_cbranch_vccnz f_56e12
f_56b12:
    v_cmp_eq_u32 vcc, -1, v27
    s_nop 0
    s_cbranch_vccnz re_61
bk_62:
    buffer_load_dwordx4 v[76:79], v4, s[16:19], s53 offen offset:896 sc1
    s_waitcnt lgkmcnt(4)
    v_mfma_f32_32x32x16_bf16 v[96:111], a[96:99], v[80:83], v[96:111]
    v_cmp_eq_u32 vcc, -1, v84
    v_mfma_f32_32x32x16_bf16 v[112:127], a[100:103], v[80:83], v[112:127]
    s_cbranch_vccnz f_56e13
f_56b13:
    s_add_u32 s53, s46, s20
    buffer_load_dwordx4 v[80:83], v4, s[16:19], s53 offen offset:0 sc1
    s_waitcnt lgkmcnt(0)
    v_mfma_f32_32x32x16_bf16 v[96:111], a[104:107], v[84:87], v[96:111]
    v_cmp_eq_u32 vcc, -1, v88
    v_mfma_f32_32x32x16_bf16 v[112:127], a[108:111], v[84:87], v[112:127]
    s_cbranch_vccnz f_56e14
f_56b14:
    buffer_load_dwordx4 v[84:87], v4, s[16:19], s53 offen offset:896 sc1
    v_mfma_f32_32x32x16_bf16 v[128:143], a[0:3], v[88:91], 0
    v_cmp_eq_u32 vcc, -1, v92
    v_mfma_f32_32x32x16_bf16 v[144:159], a[4:7], v[88:91], 0
    s_cbranch_vccnz f_56e15
f_56b15:
    s_nop 3
    v_cmp_u_f32 vcc, v96, v96
    s_nop 0
    s_cbranch_vccnz redo_65
back_66:
    s_add_u32 s53, s47, s20
    buffer_load_dwordx4 v[88:91], v4, s[16:19], s53 offen offset:0 sc1
    v_mfma_f32_32x32x16_bf16 v[128:143], a[8:11], v[92:95], v[128:143]
    ds_write_b128 v17, v[104:107] offset:0
    s_waitcnt vmcnt(16)
    v_cmp_eq_u32 vcc, -1, v32
    v_mfma_f32_32x32x16_bf16 v[144:159], a[12:15], v[92:95], v[144:159]
    s_cbranch_vccnz f_56e16
f_56b16:
    ds_write_b128 v17, v[108:111] offset:1024
    buffer_load_dwordx4 v[92:95], v4, s[16:19], s53 offen offset:896 sc1
    v_mfma_f32_32x32x16_bf16 v[128:143], a[16:19], v[32:35], v[128:143]
    ds_write_b128 v18, v[112:115] offset:0
    s_waitcnt vmcnt(16)
    v_cmp_eq_u32 vcc, -1, v36
    v_mfma_f32_32x32x16_bf16 v[144:159], a[20:23], v[32:35], v[144:159]
    s_cbranch_vccnz f_56e17
f_56b17:
    buffer_load_dword v25, v16, s[16:19], s95 offen sc1
    s_add_u32 s53, s91, s20
    buffer_load_dwordx4 v[32:35], v4, s[16:19], s53 offen offset:0 sc1
    v_mfma_f32_32x32x16_bf16 v[128:143], a[24:27], v[36:39], v[128:143]
    ds_write_b128 v18, v[116:119] offset:1024
    s_waitcnt vmcnt(17)
    v_cmp_eq_u32 vcc, -1, v40
    v_mfma_f32_32x32x16_bf16 v[144:159], a[28:31], v[36:39], v[144:159]
    s_cbranch_vccnz f_56e18
f_56b18:
    ds_write_b128 v19, v[120:123] offset:0
    buffer_load_dwordx4 v[36:39], v4, s[16:19], s53 offen offset:896 sc1
    v_mfma_f32_32x32x16_bf16 v[128:143], a[32:35], v[40:43], v[128:143]
    ds_write_b128 v19, v[124:127] offset:1024
    s_waitcnt vmcnt(17)
    v_cmp_eq_u32 vcc, -1, v44
    v_mfma_f32_32x32x16_bf16 v[144:159], a[36:39], v[40:43], v[144:159]
    s_cbranch_vccnz f_56e19
f_56b19:
    s_add_u32 s53, s92, s20
    buffer_load_dwordx4 v[40:43], v4, s[16:19], s53 offen offset:0 sc1
    v_mfma_f32_32x32x16_bf16 v[128:143], a[40:43], v[44:47], v[128:143]
    s_waitcnt lgkmcnt(0)
    s_barrier
    ds_read_b128 v[168:171], v14 offset:0
    ds_read_b128 v[172:175], v14 offset:1024
    ds_read_b128 v[176:179], v14 offset:2048
    s_waitcnt vmcnt(17)
    v_cmp_eq_u32 vcc, -1, v48
    v_mfma_f32_32x32x16_bf16 v[144:159], a[44:47], v[44:47], v[144:159]
    s_cbranch_vccnz f_56e20
f_56b20:
    ds_read_b128 v[180:183], v14 offset:3072
    ds_read_b128 v[184:187], v14 offset:4096
    ds_read_b128 v[188:191], v14 offset:5120
    buffer_load_dwordx4 v[44:47], v4, s[16:19], s53 offen offset:896 sc1
    v_mfma_f32_32x32x16_bf16 v[128:143], a[48:51], v[48:51], v[128:143]
    s_waitcnt lgkmcnt(4)
    v_add_f32 v160, v96, v168
    v_add_f32 v161, v97, v169
    v_add_f32 v162, v98, v170
    v_add_f32 v163, v99, v171
    v_add_f32 v164, v100, v172
    s_waitcnt vmcnt(15)
    v_cmp_eq_u32 vcc, -1, v52
    v_mfma_f32_32x32x16_bf16 v[144:159], a[52:55], v[48:51], v[144:159]
    s_cbranch_vccnz f_56e21
f_56b21:
    v_add_f32 v165, v101, v173
    v_add_f32 v166, v102, v174
    v_add_f32 v167, v103, v175
    s_add_u32 s53, s51, s20
    buffer_load_dwordx4 v[48:51], v4, s[16:19], s53 offen offset:0 sc1
    v_mfma_f32_32x32x16_bf16 v[128:143], a[56:59], v[52:55], v[128:143]
    s_waitcnt lgkmcnt(2)
    v_add_f32 v160, v160, v176
    v_add_f32 v161, v161, v177
    v_add_f32 v162, v162, v178
    v_add_f32 v163, v163, v179
    v_add_f32 v164, v164, v180
    s_waitcnt vmcnt(15)
    v_cmp_eq_u32 vcc, -1, v56
    v_mfma_f32_32x32x16_bf16 v[144:159], a[60:63], v[52:55], v[144:159]
    s_cbranch_vccnz f_56e22
f_56b22:
    v_add_f32 v165, v165, v181
    v_add_f32 v166, v166, v182
    v_add_f32 v167, v167, v183
    s_waitcnt lgkmcnt(0)
    buffer_load_dwordx4 v[52:55], v4, s[16:19], s53 offen offset:896 sc1
    v_mfma_f32_32x32x16_bf16 v[128:143], a[64:67], v[56:59], v[128:143]
    v_add_f32 v160, v160, v184
    v_add_f32 v161, v161, v185
    v_add_f32 v162, v162, v186
    v_add_f32 v163, v163, v187
    v_add_f32 v164, v164, v188
    v_add_f32 v165, v165, v189
    s_waitcnt vmcnt(15)
    v_cmp_eq_u32 vcc, -1, v60
    v_mfma_f32_32x32x16_bf16 v[144:159], a[68:71], v[56:59], v[144:159]
    s_cbranch_vccnz f_56e23
f_56b23:
    v_add_f32 v166, v166, v190
    v_add_f32 v167, v167, v191
    v_cvt_pk_bf16_f32 v244, v160, v161
    s_add_u32 s53, s62, s20
    buffer_load_dwordx4 v[56:59], v4, s[16:19], s53 offen offset:0 sc1
    v_mfma_f32_32x32x16_bf16 v[128:143], a[72:75], v[60:63], v[128:143]
    v_cvt_pk_bf16_f32 v245, v162, v163
    v_cvt_pk_bf16_f32 v246, v164, v165
    v_cvt_pk_bf16_f32 v248, v166, v167
    buffer_store_dwordx4 v[244:247], v3, s[16:19], s93 offen offset:0 sc1
    s_waitcnt vmcnt(16)
    v_cmp_eq_u32 vcc, -1, v64
    v_mfma_f32_32x32x16_bf16 v[144:159], a[76:79], v[60:63], v[144:159]
    s_cbranch_vccnz f_56e24
f_56b24:
    buffer_store_dwordx2 v[248:249], v8, s[16:19], s93 offen offset:1024 sc1
    buffer_load_dwordx4 v[60:63], v4, s[16:19], s53 offen offset:896 sc1
    v_mfma_f32_32x32x16_bf16 v[128:143], a[80:83], v[64:67], v[128:143]
    v_lshlrev_b32 v168, 16, v208
    v_and_b32 v169, 0xffff0000, v208
    v_lshlrev_b32 v170, 16, v209
    v_and_b32 v171, 0xffff0000, v209
    v_lshlrev_b32 v172, 16, v210
    s_waitcnt vmcnt(17)
    v_cmp_eq_u32 vcc, -1, v68
    v_mfma_f32_32x32x16_bf16 v[144:159], a[84:87], v[64:67], v[144:159]
    s_cbranch_vccnz f_56e25
f_56b25:
    v_and_b32 v173, 0xffff0000, v210
    v_lshlrev_b32 v174, 16, v211
    s_add_u32 s53, s100, s20
    buffer_load_dwordx4 v[64:67], v4, s[16:19], s53 offen offset:0 sc1
    v_mfma_f32_32x32x16_bf16 v[128:143], a[88:91], v[68:71], v[128:143]
    v_and_b32 v175, 0xffff0000, v211
    v_lshlrev_b32 v176, 16, v212
    v_and_b32 v177, 0xffff0000, v212
    v_lshlrev_b32 v178, 16, v213
    v_and_b32 v179, 0xffff0000, v213
    s_waitcnt vmcnt(17)
    v_cmp_eq_u32 vcc, -1, v72
    v_mfma_f32_32x32x16_bf16 v[144:159], a[92:95], v[68:71], v[144:159]
    s_cbranch_vccnz f_56e26
f_56b26:
    v_lshlrev_b32 v180, 16, v214
    s_waitcnt vmcnt(11)
    v_cmp_eq_u32 vcc, -1, v25
    s_nop 0
    s_cbranch_vccnz re_63
bk_64:
    buffer_load_dwordx4 v[68:71], v4, s[16:19], s53 offen offset:896 sc1
    v_mfma_f32_32x32x16_bf16 v[128:143], a[96:99], v[72:75], v[128:143]
    v_and_b32 v181, 0xffff0000, v214
    v_lshlrev_b32 v182, 16, v215
    v_and_b32 v183, 0xffff0000, v215
    v_add_f32 v192, v200, v168
    v_add_f32 v193, v201, v169
    v_cmp_eq_u32 vcc, -1, v76
    v_mfma_f32_32x32x16_bf16 v[144:159], a[100:103], v[72:75], v[144:159]
    s_cbranch_vccnz f_56e27
f_56b27:
    v_add_f32 v194, v202, v170
    v_add_f32 v195, v203, v171
    v_add_f32 v196, v204, v172
    s_add_u32 s53, s46, s21
    buffer_load_dwordx4 v[72:75], v4, s[16:19], s53 offen offset:0 sc1
    v_mfma_f32_32x32x16_bf16 v[128:143], a[104:107], v[76:79], v[128:143]
    v_add_f32 v197, v205, v173
    v_add_f32 v198, v206, v174
    v_add_f32 v199, v207, v175
    v_add_f32 v200, v200, v176
    v_add_f32 v201, v201, v177
    v_add_f32 v202, v202, v178
    v_add_f32 v203, v203, v179
    v_add_f32 v204, v204, v180
    v_mfma_f32_32x32x16_bf16 v[144:159], a[108:111], v[76:79], v[144:159]
    v_add_f32 v205, v205, v181
    v_add_f32 v206, v206, v182
    v_add_f32 v207, v207, v183
    buffer_load_dwordx4 v[76:79], v4, s[16:19], s53 offen offset:896 sc1
    v_mfma_f32_32x32x16_bf16 v[96:111], a[0:3], v[80:83], 0
    v_mfma_f32_32x32x16_bf16 v[112:127], a[4:7], v[80:83], 0
    v_cmp_u_f32 vcc, v128, v128
    s_nop 0
    s_cbranch_vccnz redo_67
back_68:
    s_add_u32 s53, s47, s21
    buffer_load_dwordx4 v[80:83], v4, s[16:19], s53 offen offset:0 sc1
    v_mfma_f32_32x32x16_bf16 v[96:111], a[8:11], v[84:87], v[96:111]
    ds_write_b128 v17, v[136:139] offset:24576
    v_mfma_f32_32x32x16_bf16 v[112:127], a[12:15], v[84:87], v[112:127]
    ds_write_b128 v17, v[140:143] offset:25600
    buffer_load_dwordx4 v[84:87], v4, s[16:19], s53 offen offset:896 sc1
    v_mfma_f32_32x32x16_bf16 v[96:111], a[16:19], v[88:91], v[96:111]
    ds_write_b128 v18, v[144:147] offset:24576
    v_mfma_f32_32x32x16_bf16 v[112:127], a[20:23], v[88:91], v[112:127]
    ds_write_b128 v18, v[148:151] offset:25600
    s_add_u32 s53, s91, s21
    buffer_load_dwordx4 v[88:91], v4, s[16:19], s53 offen offset:0 sc1
    v_mfma_f32_32x32x16_bf16 v[96:111], a[24:27], v[92:95], v[96:111]
    ds_write_b128 v19, v[152:155] offset:24576
    v_mfma_f32_32x32x16_bf16 v[112:127], a[28:31], v[92:95], v[112:127]
    ds_write_b128 v19, v[156:159] offset:25600
    buffer_load_dwordx4 v[92:95], v4, s[16:19], s53 offen offset:896 sc1
    s_waitcnt vmcnt(17)
    v_mfma_f32_32x32x16_bf16 v[96:111], a[32:35], v[32:35], v[96:111]
    v_mfma_f32_32x32x16_bf16 v[112:127], a[36:39], v[32:35], v[112:127]
    s_waitcnt lgkmcnt(0)
    s_barrier
    ds_read_b128 v[168:171], v14 offset:24576
    s_add_u32 s53, s92, s21
    buffer_load_dwordx4 v[32:35], v4, s[16:19], s53 offen offset:0 sc1
    s_waitcnt vmcnt(17)
    v_mfma_f32_32x32x16_bf16 v[96:111], a[40:43], v[36:39], v[96:111]
    ds_read_b128 v[172:175], v14 offset:25600
    ds_read_b128 v[176:179], v14 offset:26624
    ds_read_b128 v[180:183], v14 offset:27648
    ds_read_b128 v[184:187], v14 offset:28672
    ds_read_b128 v[188:191], v14 offset:29696
    v_mfma_f32_32x32x16_bf16 v[112:127], a[44:47], v[36:39], v[112:127]
    s_waitcnt lgkmcnt(4)
    v_add_f32 v160, v128, v168
    v_add_f32 v161, v129, v169
    v_add_f32 v162, v130, v170
    buffer_load_dwordx4 v[36:39], v4, s[16:19], s53 offen offset:896 sc1
    s_waitcnt vmcnt(17)
    v_mfma_f32_32x32x16_bf16 v[96:111], a[48:51], v[40:43], v[96:111]
    v_add_f32 v163, v131, v171
    v_add_f32 v164, v132, v172
    v_add_f32 v165, v133, v173
    v_add_f32 v166, v134, v174
    v_add_f32 v167, v135, v175
    s_waitcnt lgkmcnt(2)
    v_add_f32 v160, v160, v176
    v_add_f32 v161, v161, v177
    v_mfma_f32_32x32x16_bf16 v[112:127], a[52:55], v[40:43], v[112:127]
    v_add_f32 v162, v162, v178
    v_add_f32 v163, v163, v179
    v_add_f32 v164, v164, v180
    s_add_u32 s53, s51, s21
    buffer_load_dwordx4 v[40:43], v4, s[16:19], s53 offen offset:0 sc1
    s_waitcnt vmcnt(17)
    v_mfma_f32_32x32x16_bf16 v[96:111], a[56:59], v[44:47], v[96:111]
    v_add_f32 v165, v165, v181
    v_add_f32 v166, v166, v182
    v_add_f32 v167, v167, v183
    s_waitcnt lgkmcnt(0)
    v_add_f32 v160, v160, v184
    v_add_f32 v161, v161, v185
    v_add_f32 v162, v162, v186
    v_add_f32 v163, v163, v187
    v_mfma_f32_32x32x16_bf16 v[112:127], a[60:63], v[44:47], v[112:127]
    v_add_f32 v164, v164, v188
    v_add_f32 v165, v165, v189
    v_add_f32 v166, v166, v190
    v_add_f32 v167, v167, v191
    buffer_load_dwordx4 v[44:47], v4, s[16:19], s53 offen offset:896 sc1
    s_waitcnt vmcnt(17)
    v_mfma_f32_32x32x16_bf16 v[96:111], a[64:67], v[48:51], v[96:111]
    v_cvt_pk_bf16_f32 v244, v160, v161
    v_cvt_pk_bf16_f32 v245, v162, v163
    v_cvt_pk_bf16_f32 v246, v164, v165
    v_cvt_pk_bf16_f32 v248, v166, v167
    buffer_store_dwordx4 v[244:247], v3, s[16:19], s93 offen offset:2048 sc1
    v_mfma_f32_32x32x16_bf16 v[112:127], a[68:71], v[48:51], v[112:127]
    buffer_store_dwordx2 v[248:249], v8, s[16:19], s93 offen offset:3072 sc1
    s_add_u32 s53, s62, s21
    buffer_load_dwordx4 v[48:51], v4, s[16:19], s53 offen offset:0 sc1
    s_waitcnt vmcnt(19)
    v_mfma_f32_32x32x16_bf16 v[96:111], a[72:75], v[52:55], v[96:111]
    v_mfma_f32_32x32x16_bf16 v[112:127], a[76:79], v[52:55], v[112:127]
    buffer_load_dwordx4 v[52:55], v4, s[16:19], s53 offen offset:896 sc1
    s_waitcnt vmcnt(19)
    v_mfma_f32_32x32x16_bf16 v[96:111], a[80:83], v[56:59], v[96:111]
    v_mfma_f32_32x32x16_bf16 v[112:127], a[84:87], v[56:59], v[112:127]
    s_add_u32 s53, s100, s21
    buffer_load_dwordx4 v[56:59], v4, s[16:19], s53 offen offset:0 sc1
    s_waitcnt vmcnt(17)
    v_mfma_f32_32x32x16_bf16 v[96:111], a[88:91], v[60:63], v[96:111]
    v_mfma_f32_32x32x16_bf16 v[112:127], a[92:95], v[60:63], v[112:127]
    buffer_load_dwordx4 v[60:63], v4, s[16:19], s53 offen offset:896 sc1
    s_waitcnt vmcnt(17)
    v_mfma_f32_32x32x16_bf16 v[96:111], a[96:99], v[64:67], v[96:111]
    v_mfma_f32_32x32x16_bf16 v[112:127], a[100:103], v[64:67], v[112:127]
    s_waitcnt vmcnt(16)
    v_mfma_f32_32x32x16_bf16 v[96:111], a[104:107], v[68:71], v[96:111]
    v_mfma_f32_32x32x16_bf16 v[112:127], a[108:111], v[68:71], v[112:127]
    s_waitcnt vmcnt(15)
    v_mfma_f32_32x32x16_bf16 v[128:143], a[0:3], v[72:75], 0
    v_mfma_f32_32x32x16_bf16 v[144:159], a[4:7], v[72:75], 0
    s_nop 7
    v_cmp_u_f32 vcc, v96, v96
    s_nop 0
    s_cbranch_vccnz redo_69
back_70:
    ds_write_b128 v17, v[104:107] offset:0
    s_waitcnt vmcnt(14)
    v_mfma_f32_32x32x16_bf16 v[128:143], a[8:11], v[76:79], v[128:143]
    ds_write_b128 v17, v[108:111] offset:1024
    v_mfma_f32_32x32x16_bf16 v[144:159], a[12:15], v[76:79], v[144:159]
    ds_write_b128 v18, v[112:115] offset:0
    s_waitcnt vmcnt(13)
    v_mfma_f32_32x32x16_bf16 v[128:143], a[16:19], v[80:83], v[128:143]
    ds_write_b128 v18, v[116:119] offset:1024
    v_mfma_f32_32x32x16_bf16 v[144:159], a[20:23], v[80:83], v[144:159]
    ds_write_b128 v19, v[120:123] offset:0
    s_waitcnt vmcnt(12)
    v_mfma_f32_32x32x16_bf16 v[128:143], a[24:27], v[84:87], v[128:143]
    ds_write_b128 v19, v[124:127] offset:1024
    v_mfma_f32_32x32x16_bf16 v[144:159], a[28:31], v[84:87], v[144:159]
    v_add_f32 v160, v96, v192
    v_add_f32 v161, v97, v193
    v_add_f32 v162, v98, v194
    v_add_f32 v163, v99, v195
    v_add_f32 v164, v100, v196
    s_waitcnt vmcnt(11)
    v_mfma_f32_32x32x16_bf16 v[128:143], a[32:35], v[88:91], v[128:143]
    v_add_f32 v165, v101, v197
    v_add_f32 v166, v102, v198
    v_add_f32 v167, v103, v199
    s_waitcnt lgkmcnt(0)
    s_barrier
    ds_read_b128 v[168:171], v14 offset:0
    v_mfma_f32_32x32x16_bf16 v[144:159], a[36:39], v[88:91], v[144:159]
    buffer_load_dwordx4 v[216:219], v3, s[16:19], s94 offen offset:0 sc1
    buffer_load_dwordx2 v[220:221], v8, s[16:19], s94 offen offset:1024 sc1
    s_waitcnt vmcnt(12)
    v_mfma_f32_32x32x16_bf16 v[128:143], a[40:43], v[92:95], v[128:143]
    ds_read_b128 v[172:175], v14 offset:1024
    ds_read_b128 v[176:179], v14 offset:2048
    ds_read_b128 v[180:183], v14 offset:3072
    ds_read_b128 v[184:187], v14 offset:4096
    ds_read_b128 v[188:191], v14 offset:5120
    v_mfma_f32_32x32x16_bf16 v[144:159], a[44:47], v[92:95], v[144:159]
    s_waitcnt lgkmcnt(4)
    v_add_f32 v160, v160, v168
    v_add_f32 v161, v161, v169
    v_add_f32 v162, v162, v170
    v_add_f32 v163, v163, v171
    s_waitcnt vmcnt(11)
    v_mfma_f32_32x32x16_bf16 v[128:143], a[48:51], v[32:35], v[128:143]
    v_add_f32 v164, v164, v172
    v_add_f32 v165, v165, v173
    v_add_f32 v166, v166, v174
    v_add_f32 v167, v167, v175
    s_waitcnt lgkmcnt(2)
    v_add_f32 v160, v160, v176
    v_mfma_f32_32x32x16_bf16 v[144:159], a[52:55], v[32:35], v[144:159]
    v_add_f32 v161, v161, v177
    v_add_f32 v162, v162, v178
    v_add_f32 v163, v163, v179
    v_add_f32 v164, v164, v180
    v_add_f32 v165, v165, v181
    s_waitcnt vmcnt(10)
    v_mfma_f32_32x32x16_bf16 v[128:143], a[56:59], v[36:39], v[128:143]
    v_add_f32 v166, v166, v182
    v_add_f32 v167, v167, v183
    s_waitcnt lgkmcnt(0)
    v_add_f32 v160, v160, v184
    v_add_f32 v161, v161, v185
    v_add_f32 v162, v162, v186
    v_mfma_f32_32x32x16_bf16 v[144:159], a[60:63], v[36:39], v[144:159]
    v_add_f32 v163, v163, v187
    v_add_f32 v164, v164, v188
    v_add_f32 v165, v165, v189
    v_add_f32 v166, v166, v190
    v_add_f32 v167, v167, v191
    s_waitcnt vmcnt(9)
    v_mfma_f32_32x32x16_bf16 v[128:143], a[64:67], v[40:43], v[128:143]
    v_mfma_f32_32x32x16_bf16 v[144:159], a[68:71], v[40:43], v[144:159]
    s_waitcnt vmcnt(8)
    v_mfma_f32_32x32x16_bf16 v[128:143], a[72:75], v[44:47], v[128:143]
    v_mfma_f32_32x32x16_bf16 v[144:159], a[76:79], v[44:47], v[144:159]
    buffer_load_dwordx4 v[224:227], v3, s[16:19], s94 offen offset:2048 sc1
    buffer_load_dwordx2 v[228:229], v8, s[16:19], s94 offen offset:3072 sc1
    s_waitcnt vmcnt(7)
    v_mfma_f32_32x32x16_bf16 v[128:143], a[80:83], v[48:51], v[128:143]
    v_mfma_f32_32x32x16_bf16 v[144:159], a[84:87], v[48:51], v[144:159]
    s_waitcnt vmcnt(2)
    v_xor_b32 v219, s52, v219
    v_xor_b32 v221, s52, v221
    v_or_b32 v221, v219, v221
    v_mov_b32 v219, v220
    v_mfma_f32_32x32x16_bf16 v[128:143], a[88:91], v[52:55], v[128:143]
    v_cmp_ne_u32 vcc, 0, v221
    s_nop 0
    s_cbranch_vccnz xre_71
xback_72:
    v_mfma_f32_32x32x16_bf16 v[160:175], v[240:243], v[216:219], v[160:175]
    v_mfma_f32_32x32x16_bf16 v[144:159], a[92:95], v[52:55], v[144:159]
    v_mfma_f32_32x32x16_bf16 v[128:143], a[96:99], v[56:59], v[128:143]
    s_nop 9
    v_cvt_pk_bf16_f32 v176, v160, v161
    v_cvt_pk_bf16_f32 v177, v162, v163
    v_cvt_pk_bf16_f32 v178, v164, v165
    v_cvt_pk_bf16_f32 v179, v166, v167
    ds_write_b16 v15, v176 offset:0
    v_mfma_f32_32x32x16_bf16 v[144:159], a[100:103], v[56:59], v[144:159]
    ds_write_b16_d16_hi v15, v176 offset:112
    ds_write_b16 v15, v177 offset:224
    ds_write_b16_d16_hi v15, v177 offset:336
    ds_write_b16 v15, v178 offset:896
    v_mfma_f32_32x32x16_bf16 v[128:143], a[104:107], v[60:63], v[128:143]
    ds_write_b16_d16_hi v15, v178 offset:1008
    ds_write_b16 v15, v179 offset:1120
    ds_write_b16_d16_hi v15, v179 offset:1232
    v_mfma_f32_32x32x16_bf16 v[144:159], a[108:111], v[60:63], v[144:159]
    s_nop 7
    v_cmp_u_f32 vcc, v128, v128
    s_nop 0
    s_cbranch_vccnz redo_73
back_74:
    ds_write_b128 v17, v[136:139] offset:24576
    ds_write_b128 v17, v[140:143] offset:25600
    ds_write_b128 v18, v[144:147] offset:24576
    ds_write_b128 v18, v[148:151] offset:25600
    ds_write_b128 v19, v[152:155] offset:24576
    ds_write_b128 v19, v[156:159] offset:25600
    v_pk_add_f32 v[128:129], v[128:129], v[200:201]
    v_pk_add_f32 v[130:131], v[130:131], v[202:203]
    v_pk_add_f32 v[132:133], v[132:133], v[204:205]
    v_pk_add_f32 v[134:135], v[134:135], v[206:207]
    s_waitcnt lgkmcnt(0)
    s_barrier
    ds_read_b128 v[104:107], v14 offset:24576
    ds_read_b128 v[108:111], v14 offset:25600
    ds_read_b128 v[112:115], v14 offset:26624
    ds_read_b128 v[116:119], v14 offset:27648
    ds_read_b128 v[120:123], v14 offset:28672
    ds_read_b128 v[124:127], v14 offset:29696
    s_waitcnt vmcnt(0)
    v_xor_b32 v227, s52, v227
    v_xor_b32 v229, s52, v229
    v_or_b32 v229, v227, v229
    v_mov_b32 v227, v228
    v_cmp_ne_u32 vcc, 0, v229
    s_nop 0
    s_cbranch_vccnz xre_75
xback_76:
    v_mfma_f32_32x32x16_bf16 v[128:143], v[240:243], v[224:227], v[128:143]
    s_waitcnt lgkmcnt(4)
    s_nop 10
    v_pk_add_f32 v[96:97], v[128:129], v[104:105]
    v_pk_add_f32 v[98:99], v[130:131], v[106:107]
    v_pk_add_f32 v[100:101], v[132:133], v[108:109]
    v_pk_add_f32 v[102:103], v[134:135], v[110:111]
    s_waitcnt lgkmcnt(2)
    v_pk_add_f32 v[96:97], v[96:97], v[112:113]
    v_pk_add_f32 v[98:99], v[98:99], v[114:115]
    v_pk_add_f32 v[100:101], v[100:101], v[116:117]
    v_pk_add_f32 v[102:103], v[102:103], v[118:119]
    s_waitcnt lgkmcnt(0)
    v_pk_add_f32 v[96:97], v[96:97], v[120:121]
    v_pk_add_f32 v[98:99], v[98:99], v[122:123]
    v_pk_add_f32 v[100:101], v[100:101], v[124:125]
    v_pk_add_f32 v[102:103], v[102:103], v[126:127]
    v_cvt_pk_bf16_f32 v112, v96, v97
    v_cvt_pk_bf16_f32 v113, v98, v99
    v_cvt_pk_bf16_f32 v114, v100, v101
    v_cvt_pk_bf16_f32 v115, v102, v103
    ds_write_b16 v15, v112 offset:56
    ds_write_b16_d16_hi v15, v112 offset:168
    ds_write_b16 v15, v113 offset:280
    ds_write_b16_d16_hi v15, v113 offset:392
    ds_write_b16 v15, v114 offset:952
    ds_write_b16_d16_hi v15, v114 offset:1064
    ds_write_b16 v15, v115 offset:1176
    ds_write_b16_d16_hi v15, v115 offset:1288
    s_waitcnt lgkmcnt(0)
    ds_read_b128 v[160:163], v238
    ds_read_b128 v[164:167], v238 offset:1024
    s_waitcnt lgkmcnt(1)
    buffer_store_dwordx4 v[160:163], v236, s[40:43], s44 offen
    s_waitcnt lgkmcnt(0)
    buffer_store_dwordx4 v[164:167], v237, s[40:43], s44 offen
L_end:
    s_endpgm
L_cold:
re_3:
    s_add_u32 s78, s78, 1
    s_cmp_ge_u32 s78, 0x8000
    s_cbranch_scc1 bk_4
    buffer_load_dword v196, v195, s[16:19], s92 offen sc1
    s_waitcnt vmcnt(0)
    v_cmp_ne_u32 vcc, s52, v196
    s_nop 0
    s_cbranch_vccnz re_3
    s_branch bk_4
re_5:
    s_add_u32 s78, s78, 1
    s_cmp_ge_u32 s78, 0x8000
    s_cbranch_scc1 bk_6
    buffer_load_dword v196, v195, s[16:19], s92 offen sc1
    s_waitcnt vmcnt(0)
    v_cmp_ne_u32 vcc, s52, v196
    s_nop 0
    s_cbranch_vccnz re_5
    s_branch bk_6
re_7:
    s_add_u32 s78, s78, 1
    s_cmp_ge_u32 s78, 0x8000
    s_cbranch_scc1 bk_8
    buffer_load_dword v176, v5, s[16:19], s101 offen sc1
    s_waitcnt vmcnt(0)
    v_cmp_ne_u32 vcc, s52, v176
    s_nop 0
    s_cbranch_vccnz re_7
    s_branch bk_8
kv_9:
    s_waitcnt vmcnt(0)
kvl_11:
    s_add_u32 s78, s78, 1
    s_cmp_ge_u32 s78, 0x8000
    s_cbranch_scc1 kvb_10
    s_lshr_b32 s89, s49, 1
    s_lshl_b32 s89, s89, 13
    v_cmp_eq_u32 vcc, -1, v32
    s_nop 0
    s_cbranch_vccz kvn_12
    buffer_load_dwordx4 v[32:35], v251, s[16:19], s89 offen offset:0 sc1
kvn_12:
    v_cmp_eq_u32 vcc, -1, v36
    s_nop 0
    s_cbranch_vccz kvn_13
    buffer_load_dwordx4 v[36:39], v251, s[16:19], s89 offen offset:256 sc1
kvn_13:
    s_add_u32 s89, s89, 8192
    s_and_b32 s89, s89, 0xffff
    v_cmp_eq_u32 vcc, -1, v40
    s_nop 0
    s_cbranch_vccz kvn_14
    buffer_load_dwordx4 v[40:43], v251, s[16:19], s89 offen offset:0 sc1
kvn_14:
    v_cmp_eq_u32 vcc, -1, v44
    s_nop 0
    s_cbranch_vccz kvn_15
    buffer_load_dwordx4 v[44:47], v251, s[16:19], s89 offen offset:256 sc1
kvn_15:
    s_add_u32 s89, s89, 8192
    s_and_b32 s89, s89, 0xffff
    v_cmp_eq_u32 vcc, -1, v48
    s_nop 0
    s_cbranch_vccz kvn_16
    buffer_load_dwordx4 v[48:51], v251, s[16:19], s89 offen offset:0 sc1
kvn_16:
    v_cmp_eq_u32 vcc, -1, v52
    s_nop 0
    s_cbranch_vccz kvn_17
    buffer_load_dwordx4 v[52:55], v251, s[16:19], s89 offen offset:256 sc1
kvn_17:
    s_add_u32 s89, s89, 8192
    s_and_b32 s89, s89, 0xffff
    v_cmp_eq_u32 vcc, -1, v56
    s_nop 0
    s_cbranch_vccz kvn_18
    buffer_load_dwordx4 v[56:59], v251, s[16:19], s89 offen offset:0 sc1
kvn_18:
    v_cmp_eq_u32 vcc, -1, v60
    s_nop 0
    s_cbranch_vccz kvn_19
    buffer_load_dwordx4 v[60:63], v251, s[16:19], s89 offen offset:256 sc1
kvn_19:
    s_add_u32 s89, s89, 8192
    s_and_b32 s89, s89, 0xffff
    v_cmp_eq_u32 vcc, -1, v64
    s_nop 0
    s_cbranch_vccz kvn_20
    buffer_load_dwordx4 v[64:67], v251, s[16:19], s89 offen offset:0 sc1
kvn_20:
    v_cmp_eq_u32 vcc, -1, v68
    s_nop 0
    s_cbranch_vccz kvn_21
    buffer_load_dwordx4 v[68:71], v251, s[16:19], s89 offen offset:256 sc1
kvn_21:
    s_add_u32 s89, s89, 8192
    s_and_b32 s89, s89, 0xffff
    v_cmp_eq_u32 vcc, -1, v72
    s_nop 0
    s_cbranch_vccz kvn_22
    buffer_load_dwordx4 v[72:75], v251, s[16:19], s89 offen offset:0 sc1
kvn_22:
    v_cmp_eq_u32 vcc, -1, v76
    s_nop 0
    s_cbranch_vccz kvn_23
    buffer_load_dwordx4 v[76:79], v251, s[16:19], s89 offen offset:256 sc1
kvn_23:
    s_add_u32 s89, s89, 8192
    s_and_b32 s89, s89, 0xffff
    v_cmp_eq_u32 vcc, -1, v80
    s_nop 0
    s_cbranch_vccz kvn_24
    buffer_load_dwordx4 v[80:83], v251, s[16:19], s89 offen offset:0 sc1
kvn_24:
    v_cmp_eq_u32 vcc, -1, v84
    s_nop 0
    s_cbranch_vccz kvn_25
    buffer_load_dwordx4 v[84:87], v251, s[16:19], s89 offen offset:256 sc1
kvn_25:
    s_add_u32 s89, s89, 8192
    s_and_b32 s89, s89, 0xffff
    v_cmp_eq_u32 vcc, -1, v88
    s_nop 0
    s_cbranch_vccz kvn_26
    buffer_load_dwordx4 v[88:91], v251, s[16:19], s89 offen offset:0 sc1
kvn_26:
    v_cmp_eq_u32 vcc, -1, v92
    s_nop 0
    s_cbranch_vccz kvn_27
    buffer_load_dwordx4 v[92:95], v251, s[16:19], s89 offen offset:256 sc1
kvn_27:
    s_add_u32 s89, s89, 8192
    s_and_b32 s89, s89, 0xffff
    s_waitcnt vmcnt(0)
    v_mfma_f32_16x16x32_bf16 v[96:99], v[180:183], v[32:35], 0
    v_mfma_f32_16x16x32_bf16 v[100:103], v[180:183], v[36:39], 0
    v_mfma_f32_16x16x32_bf16 v[96:99], v[180:183], v[40:43], v[96:99]
    v_mfma_f32_16x16x32_bf16 v[100:103], v[180:183], v[44:47], v[100:103]
    v_mfma_f32_16x16x32_bf16 v[96:99], v[180:183], v[48:51], v[96:99]
    v_mfma_f32_16x16x32_bf16 v[100:103], v[180:183], v[52:55], v[100:103]
    v_mfma_f32_16x16x32_bf16 v[96:99], v[180:183], v[56:59], v[96:99]
    v_mfma_f32_16x16x32_bf16 v[100:103], v[180:183], v[60:63], v[100:103]
    v_mfma_f32_16x16x32_bf16 v[96:99], v[180:183], v[64:67], v[96:99]
    v_mfma_f32_16x16x32_bf16 v[100:103], v[180:183], v[68:71], v[100:103]
    v_mfma_f32_16x16x32_bf16 v[96:99], v[180:183], v[72:75], v[96:99]
    v_mfma_f32_16x16x32_bf16 v[100:103], v[180:183], v[76:79], v[100:103]
    v_mfma_f32_16x16x32_bf16 v[96:99], v[180:183], v[80:83], v[96:99]
    v_mfma_f32_16x16x32_bf16 v[100:103], v[180:183], v[84:87], v[100:103]
    v_mfma_f32_16x16x32_bf16 v[96:99], v[180:183], v[88:91], v[96:99]
    v_mfma_f32_16x16x32_bf16 v[100:103], v[180:183], v[92:95], v[100:103]
    s_nop 7
    v_cmp_u_f32 vcc, v96, v100
    v_cvt_pk_bf16_f32 v112, v96, v97
    v_cvt_pk_bf16_f32 v113, v98, v99
    v_cvt_pk_bf16_f32 v114, v100, v101
    v_cvt_pk_bf16_f32 v115, v102, v103
    s_cbranch_vccnz kvl_11
    s_branch kvb_10
olp_29:
    s_add_u32 s78, s78, 1
    s_cmp_ge_u32 s78, 0x8000
    s_cbranch_scc1 olb_30
    v_min_u32 v25, 27, v1
    v_and_b32 v23, 1, v25
    v_lshrrev_b32 v25, 1, v25
    v_lshlrev_b32 v25, 9, v25
    v_lshl_add_u32 v25, v23, 3, v25
    v_add_u32 v25, 500, v25
poll_31:
    buffer_load_dword v23, v25, s[16:19], s5 offen sc1
    s_waitcnt vmcnt(0)
    v_cmp_eq_u32 vcc, -1, v23
    s_nop 0
    s_cbranch_vccz pdone_32
    s_add_u32 s78, s78, 1
    s_cmp_lt_u32 s78, 0x8000
    s_cbranch_scc1 poll_31
pdone_32:
    s_branch ol_28
re_33:
    s_add_u32 s78, s78, 1
    s_cmp_ge_u32 s78, 0x8000
    s_cbranch_scc1 bk_34
    buffer_load_dword v27, v5, s[16:19], s101 offen sc1
    s_waitcnt vmcnt(0)
    v_cmp_ne_u32 vcc, s52, v27
    s_nop 0
    s_cbranch_vccnz re_33
    s_branch bk_34
idle_37:
    buffer_store_dwordx4 v[208:211], v4, s[16:19], s79 offen sc1
    buffer_store_dwordx4 v[212:215], v4, s[16:19], s79 offen offset:896 sc1
    s_waitcnt vmcnt(2)
    ds_read_b64_tr_b16 a[16:17], v234 offset:24576
    ds_read_b64_tr_b16 a[18:19], v234 offset:25600
    ds_read_b64_tr_b16 a[20:21], v235 offset:24576
    ds_read_b64_tr_b16 a[22:23], v235 offset:25600
    ds_read_b64_tr_b16 a[24:25], v234 offset:32768
    ds_read_b64_tr_b16 a[26:27], v234 offset:33792
    ds_read_b64_tr_b16 a[28:29], v235 offset:32768
    ds_read_b64_tr_b16 a[30:31], v235 offset:33792
    ds_read_b64_tr_b16 a[32:33], v234 offset:40960
    ds_read_b64_tr_b16 a[34:35], v234 offset:41984
    ds_read_b64_tr_b16 a[36:37], v235 offset:40960
    ds_read_b64_tr_b16 a[38:39], v235 offset:41984
    ds_read_b64_tr_b16 a[40:41], v232 offset:0
    ds_read_b64_tr_b16 a[42:43], v232 offset:1024
    ds_read_b64_tr_b16 a[44:45], v233 offset:0
    ds_read_b64_tr_b16 a[46:47], v233 offset:1024
    s_waitcnt lgkmcnt(0)
    s_xor_b32 s101, s72, 512
    buffer_load_dwordx4 v[96:99], v11, s[28:31], s101 offen
    buffer_load_dwordx4 v[100:103], v12, s[28:31], s101 offen offset:1024
    s_add_u32 s101, s101, 65536
    buffer_load_dwordx4 v[104:107], v11, s[28:31], s101 offen
    buffer_load_dwordx4 v[108:111], v12, s[28:31], s101 offen offset:1024
    s_xor_b32 s101, s73, 512
    buffer_load_dwordx4 v[112:115], v11, s[28:31], s101 offen
    buffer_load_dwordx4 v[116:119], v12, s[28:31], s101 offen offset:1024
    s_add_u32 s101, s101, 65536
    buffer_load_dwordx4 v[120:123], v11, s[28:31], s101 offen
    buffer_load_dwordx4 v[124:127], v12, s[28:31], s101 offen offset:1024
    s_xor_b32 s101, s74, 512
    buffer_load_dwordx4 v[128:131], v11, s[28:31], s101 offen
    buffer_load_dwordx4 v[132:135], v12, s[28:31], s101 offen offset:1024
    s_add_u32 s101, s101, 65536
    buffer_load_dwordx4 v[136:139], v11, s[28:31], s101 offen
    buffer_load_dwordx4 v[140:143], v12, s[28:31], s101 offen offset:1024
    s_xor_b32 s101, s75, 512
    buffer_load_dwordx4 v[144:147], v11, s[28:31], s101 offen
    buffer_load_dwordx4 v[148:151], v12, s[28:31], s101 offen offset:1024
    s_add_u32 s101, s101, 65536
    buffer_load_dwordx4 v[152:155], v11, s[28:31], s101 offen
    buffer_load_dwordx4 v[156:159], v12, s[28:31], s101 offen offset:1024
    s_xor_b32 s101, s76, 512
    buffer_load_dwordx4 v[96:99], v11, s[28:31], s101 offen
    buffer_load_dwordx4 v[100:103], v12, s[28:31], s101 offen offset:1024
    s_add_u32 s101, s101, 65536
    buffer_load_dwordx4 v[104:107], v11, s[28:31], s101 offen
    buffer_load_dwordx4 v[108:111], v12, s[28:31], s101 offen offset:1024
    s_xor_b32 s101, s77, 512
    buffer_load_dwordx4 v[112:115], v11, s[28:31], s101 offen
    buffer_load_dwordx4 v[116:119], v12, s[28:31], s101 offen offset:1024
    s_add_u32 s101, s101, 65536
    buffer_load_dwordx4 v[120:123], v11, s[28:31], s101 offen
    buffer_load_dwordx4 v[124:127], v12, s[28:31], s101 offen offset:1024
    s_xor_b32 s101, s71, 512
    buffer_load_dwordx4 v[128:131], v11, s[28:31], s101 offen
    buffer_load_dwordx4 v[132:135], v12, s[28:31], s101 offen offset:1024
    s_add_u32 s101, s101, 65536
    buffer_load_dwordx4 v[136:139], v11, s[28:31], s101 offen
    buffer_load_dwordx4 v[140:143], v12, s[28:31], s101 offen offset:1024
    s_add_u32 m0, s90, 0
    s_nop 0
    buffer_load_dwordx4 v11, s[28:31], s74 offen lds
    buffer_load_dwordx4 v12, s[28:31], s74 offen offset:1024 lds
    s_add_u32 m0, s90, 8192
    s_add_u32 s88, s74, 65536
    buffer_load_dwordx4 v11, s[28:31], s88 offen lds
    buffer_load_dwordx4 v12, s[28:31], s88 offen offset:1024 lds
    s_add_u32 m0, s90, 16384
    s_nop 0
    buffer_load_dwordx4 v11, s[28:31], s75 offen lds
    buffer_load_dwordx4 v12, s[28:31], s75 offen offset:1024 lds
    s_add_u32 m0, s90, 24576
    s_add_u32 s88, s75, 65536
    buffer_load_dwordx4 v11, s[28:31], s88 offen lds
    buffer_load_dwordx4 v12, s[28:31], s88 offen offset:1024 lds
    s_add_u32 m0, s90, 32768
    s_nop 0
    buffer_load_dwordx4 v11, s[28:31], s76 offen lds
    buffer_load_dwordx4 v12, s[28:31], s76 offen offset:1024 lds
    s_add_u32 m0, s90, 40960
    s_add_u32 s88, s76, 65536
    buffer_load_dwordx4 v11, s[28:31], s88 offen lds
    buffer_load_dwordx4 v12, s[28:31], s88 offen offset:1024 lds
    s_add_u32 m0, s90, 49152
    s_nop 0
    buffer_load_dwordx4 v11, s[28:31], s77 offen lds
    buffer_load_dwordx4 v12, s[28:31], s77 offen offset:1024 lds
    s_add_u32 m0, s90, 57344
    s_add_u32 s88, s77, 65536
    buffer_load_dwordx4 v11, s[28:31], s88 offen lds
    buffer_load_dwordx4 v12, s[28:31], s88 offen offset:1024 lds
    s_waitcnt vmcnt(0)
    buffer_store_dword v247, v0, s[16:19], s99 offen sc1
    s_branch L_spec
re_42:
    s_add_u32 s78, s78, 1
    s_cmp_ge_u32 s78, 0x8000
    s_cbranch_scc1 bk_43
    buffer_load_dword v27, v31, s[16:19], s55 offen sc1
    s_waitcnt vmcnt(0)
    v_cmp_eq_u32 vcc, -1, v27
    s_nop 0
    s_cbranch_vccnz re_42
    s_branch bk_43
redo_44:
    s_waitcnt vmcnt(0)
    s_add_u32 s78, s78, 64
    s_cmp_ge_u32 s78, 0x8000
    s_cbranch_scc1 back_45
    s_add_u32 s101, s68, s4
    buffer_load_dwordx4 a[240:243], v4, s[16:19], s101 offen offset:0 sc1
    buffer_load_dwordx4 a[244:247], v4, s[16:19], s101 offen offset:896 sc1
    buffer_load_dwordx4 a[248:251], v4, s[16:19], s101 offen offset:1792 sc1
    buffer_load_dwordx4 a[252:255], v4, s[16:19], s101 offen offset:2688 sc1
    s_waitcnt vmcnt(0)
    v_mfma_f32_32x32x16_bf16 v[96:111], a[112:115], a[240:243], 0
    v_mfma_f32_32x32x16_bf16 v[112:127], a[116:119], a[240:243], 0
    v_mfma_f32_32x32x16_bf16 v[96:111], a[120:123], a[244:247], v[96:111]
    v_mfma_f32_32x32x16_bf16 v[112:127], a[124:127], a[244:247], v[112:127]
    v_mfma_f32_32x32x16_bf16 v[96:111], a[128:131], a[248:251], v[96:111]
    v_mfma_f32_32x32x16_bf16 v[112:127], a[132:135], a[248:251], v[112:127]
    v_mfma_f32_32x32x16_bf16 v[96:111], a[136:139], a[252:255], v[96:111]
    v_mfma_f32_32x32x16_bf16 v[112:127], a[140:143], a[252:255], v[112:127]
    s_nop 15
    s_add_u32 s101, s69, s4
    buffer_load_dwordx4 a[240:243], v4, s[16:19], s101 offen offset:0 sc1
    buffer_load_dwordx4 a[244:247], v4, s[16:19], s101 offen offset:896 sc1
    buffer_load_dwordx4 a[248:251], v4, s[16:19], s101 offen offset:1792 sc1
    buffer_load_dwordx4 a[252:255], v4, s[16:19], s101 offen offset:2688 sc1
    s_waitcnt vmcnt(0)
    v_mfma_f32_32x32x16_bf16 v[96:111], a[144:147], a[240:243], v[96:111]
    v_mfma_f32_32x32x16_bf16 v[112:127], a[148:151], a[240:243], v[112:127]
    v_mfma_f32_32x32x16_bf16 v[96:111], a[152:155], a[244:247], v[96:111]
    v_mfma_f32_32x32x16_bf16 v[112:127], a[156:159], a[244:247], v[112:127]
    v_mfma_f32_32x32x16_bf16 v[96:111], a[160:163], a[248:251], v[96:111]
    v_mfma_f32_32x32x16_bf16 v[112:127], a[164:167], a[248:251], v[112:127]
    v_mfma_f32_32x32x16_bf16 v[96:111], a[168:171], a[252:255], v[96:111]
    v_mfma_f32_32x32x16_bf16 v[112:127], a[172:175], a[252:255], v[112:127]
    s_nop 15
    s_add_u32 s101, s70, s4
    buffer_load_dwordx4 a[240:243], v4, s[16:19], s101 offen offset:0 sc1
    buffer_load_dwordx4 a[244:247], v4, s[16:19], s101 offen offset:896 sc1
    buffer_load_dwordx4 a[248:251], v4, s[16:19], s101 offen offset:1792 sc1
    buffer_load_dwordx4 a[252:255], v4, s[16:19], s101 offen offset:2688 sc1
    s_waitcnt vmcnt(0)
    v_mfma_f32_32x32x16_bf16 v[96:111], a[176:179], a[240:243], v[96:111]
    v_mfma_f32_32x32x16_bf16 v[112:127], a[180:183], a[240:243], v[112:127]
    v_mfma_f32_32x32x16_bf16 v[96:111], a[184:187], a[244:247], v[96:111]
    v_mfma_f32_32x32x16_bf16 v[112:127], a[188:191], a[244:247], v[112:127]
    v_mfma_f32_32x32x16_bf16 v[96:111], a[192:195], a[248:251], v[96:111]
    v_mfma_f32_32x32x16_bf16 v[112:127], a[196:199], a[248:251], v[112:127]
    v_mfma_f32_32x32x16_bf16 v[96:111], a[200:203], a[252:255], v[96:111]
    v_mfma_f32_32x32x16_bf16 v[112:127], a[204:207], a[252:255], v[112:127]
    s_nop 15
    s_add_u32 s101, s45, s4
    buffer_load_dwordx4 a[240:243], v4, s[16:19], s101 offen offset:0 sc1
    buffer_load_dwordx4 a[244:247], v4, s[16:19], s101 offen offset:896 sc1
    buffer_load_dwordx4 a[248:251], v4, s[16:19], s101 offen offset:1792 sc1
    buffer_load_dwordx4 a[252:255], v4, s[16:19], s101 offen offset:2688 sc1
    s_waitcnt vmcnt(0)
    v_mfma_f32_32x32x16_bf16 v[96:111], a[208:211], a[240:243], v[96:111]
    v_mfma_f32_32x32x16_bf16 v[112:127], a[212:215], a[240:243], v[112:127]
    v_mfma_f32_32x32x16_bf16 v[96:111], a[216:219], a[244:247], v[96:111]
    v_mfma_f32_32x32x16_bf16 v[112:127], a[220:223], a[244:247], v[112:127]
    v_mfma_f32_32x32x16_bf16 v[96:111], a[224:227], a[248:251], v[96:111]
    v_mfma_f32_32x32x16_bf16 v[112:127], a[228:231], a[248:251], v[112:127]
    v_mfma_f32_32x32x16_bf16 v[96:111], a[232:235], a[252:255], v[96:111]
    v_mfma_f32_32x32x16_bf16 v[112:127], a[236:239], a[252:255], v[112:127]
    s_nop 10
    v_cmp_u_f32 vcc, v96, v96
    s_nop 15
    s_cbranch_vccnz redo_44
    s_branch back_45
redo_46:
    s_waitcnt vmcnt(0)
    s_add_u32 s78, s78, 64
    s_cmp_ge_u32 s78, 0x8000
    s_cbranch_scc1 back_47
    s_add_u32 s101, s68, s5
    buffer_load_dwordx4 a[240:243], v4, s[16:19], s101 offen offset:0 sc1
    buffer_load_dwordx4 a[244:247], v4, s[16:19], s101 offen offset:896 sc1
    buffer_load_dwordx4 a[248:251], v4, s[16:19], s101 offen offset:1792 sc1
    buffer_load_dwordx4 a[252:255], v4, s[16:19], s101 offen offset:2688 sc1
    s_waitcnt vmcnt(0)
    v_mfma_f32_32x32x16_bf16 v[128:143], a[112:115], a[240:243], 0
    v_mfma_f32_32x32x16_bf16 v[144:159], a[116:119], a[240:243], 0
    v_mfma_f32_32x32x16_bf16 v[128:143], a[120:123], a[244:247], v[128:143]
    v_mfma_f32_32x32x16_bf16 v[144:159], a[124:127], a[244:247], v[144:159]
    v_mfma_f32_32x32x16_bf16 v[128:143], a[128:131], a[248:251], v[128:143]
    v_mfma_f32_32x32x16_bf16 v[144:159], a[132:135], a[248:251], v[144:159]
    v_mfma_f32_32x32x16_bf16 v[128:143], a[136:139], a[252:255], v[128:143]
    v_mfma_f32_32x32x16_bf16 v[144:159], a[140:143], a[252:255], v[144:159]
    s_nop 15
    s_add_u32 s101, s69, s5
    buffer_load_dwordx4 a[240:243], v4, s[16:19], s101 offen offset:0 sc1
    buffer_load_dwordx4 a[244:247], v4, s[16:19], s101 offen offset:896 sc1
    buffer_load_dwordx4 a[248:251], v4, s[16:19], s101 offen offset:1792 sc1
    buffer_load_dwordx4 a[252:255], v4, s[16:19], s101 offen offset:2688 sc1
    s_waitcnt vmcnt(0)
    v_mfma_f32_32x32x16_bf16 v[128:143], a[144:147], a[240:243], v[128:143]
    v_mfma_f32_32x32x16_bf16 v[144:159], a[148:151], a[240:243], v[144:159]
    v_mfma_f32_32x32x16_bf16 v[128:143], a[152:155], a[244:247], v[128:143]
    v_mfma_f32_32x32x16_bf16 v[144:159], a[156:159], a[244:247], v[144:159]
    v_mfma_f32_32x32x16_bf16 v[128:143], a[160:163], a[248:251], v[128:143]
    v_mfma_f32_32x32x16_bf16 v[144:159], a[164:167], a[248:251], v[144:159]
    v_mfma_f32_32x32x16_bf16 v[128:143], a[168:171], a[252:255], v[128:143]
    v_mfma_f32_32x32x16_bf16 v[144:159], a[172:175], a[252:255], v[144:159]
    s_nop 15
    s_add_u32 s101, s70, s5
    buffer_load_dwordx4 a[240:243], v4, s[16:19], s101 offen offset:0 sc1
    buffer_load_dwordx4 a[244:247], v4, s[16:19], s101 offen offset:896 sc1
    buffer_load_dwordx4 a[248:251], v4, s[16:19], s101 offen offset:1792 sc1
    buffer_load_dwordx4 a[252:255], v4, s[16:19], s101 offen offset:2688 sc1
    s_waitcnt vmcnt(0)
    v_mfma_f32_32x32x16_bf16 v[128:143], a[176:179], a[240:243], v[128:143]
    v_mfma_f32_32x32x16_bf16 v[144:159], a[180:183], a[240:243], v[144:159]
    v_mfma_f32_32x32x16_bf16 v[128:143], a[184:187], a[244:247], v[128:143]
    v_mfma_f32_32x32x16_bf16 v[144:159], a[188:191], a[244:247], v[144:159]
    v_mfma_f32_32x32x16_bf16 v[128:143], a[192:195], a[248:251], v[128:143]
    v_mfma_f32_32x32x16_bf16 v[144:159], a[196:199], a[248:251], v[144:159]
    v_mfma_f32_32x32x16_bf16 v[128:143], a[200:203], a[252:255], v[128:143]
    v_mfma_f32_32x32x16_bf16 v[144:159], a[204:207], a[252:255], v[144:159]
    s_nop 15
    s_add_u32 s101, s45, s5
    buffer_load_dwordx4 a[240:243], v4, s[16:19], s101 offen offset:0 sc1
    buffer_load_dwordx4 a[244:247], v4, s[16:19], s101 offen offset:896 sc1
    buffer_load_dwordx4 a[248:251], v4, s[16:19], s101 offen offset:1792 sc1
    buffer_load_dwordx4 a[252:255], v4, s[16:19], s101 offen offset:2688 sc1
    s_waitcnt vmcnt(0)
    v_mfma_f32_32x32x16_bf16 v[128:143], a[208:211], a[240:243], v[128:143]
    v_mfma_f32_32x32x16_bf16 v[144:159], a[212:215], a[240:243], v[144:159]
    v_mfma_f32_32x32x16_bf16 v[128:143], a[216:219], a[244:247], v[128:143]
    v_mfma_f32_32x32x16_bf16 v[144:159], a[220:223], a[244:247], v[144:159]
    v_mfma_f32_32x32x16_bf16 v[128:143], a[224:227], a[248:251], v[128:143]
    v_mfma_f32_32x32x16_bf16 v[144:159], a[228:231], a[248:251], v[144:159]
    v_mfma_f32_32x32x16_bf16 v[128:143], a[232:235], a[252:255], v[128:143]
    v_mfma_f32_32x32x16_bf16 v[144:159], a[236:239], a[252:255], v[144:159]
    s_nop 10
    v_cmp_u_f32 vcc, v128, v128
    s_nop 15
    s_cbranch_vccnz redo_46
    s_branch back_47
redo_48:
    s_waitcnt vmcnt(0)
    s_add_u32 s78, s78, 64
    s_cmp_ge_u32 s78, 0x8000
    s_cbranch_scc1 back_49
    s_add_u32 s101, s68, s6
    buffer_load_dwordx4 a[240:243], v4, s[16:19], s101 offen offset:0 sc1
    buffer_load_dwordx4 a[244:247], v4, s[16:19], s101 offen offset:896 sc1
    buffer_load_dwordx4 a[248:251], v4, s[16:19], s101 offen offset:1792 sc1
    buffer_load_dwordx4 a[252:255], v4, s[16:19], s101 offen offset:2688 sc1
    s_waitcnt vmcnt(0)
    v_mfma_f32_32x32x16_bf16 v[96:111], a[112:115], a[240:243], 0
    v_mfma_f32_32x32x16_bf16 v[112:127], a[116:119], a[240:243], 0
    v_mfma_f32_32x32x16_bf16 v[96:111], a[120:123], a[244:247], v[96:111]
    v_mfma_f32_32x32x16_bf16 v[112:127], a[124:127], a[244:247], v[112:127]
    v_mfma_f32_32x32x16_bf16 v[96:111], a[128:131], a[248:251], v[96:111]
    v_mfma_f32_32x32x16_bf16 v[112:127], a[132:135], a[248:251], v[112:127]
    v_mfma_f32_32x32x16_bf16 v[96:111], a[136:139], a[252:255], v[96:111]
    v_mfma_f32_32x32x16_bf16 v[112:127], a[140:143], a[252:255], v[112:127]
    s_nop 15
    s_add_u32 s101, s69, s6
    buffer_load_dwordx4 a[240:243], v4, s[16:19], s101 offen offset:0 sc1
    buffer_load_dwordx4 a[244:247], v4, s[16:19], s101 offen offset:896 sc1
    buffer_load_dwordx4 a[248:251], v4, s[16:19], s101 offen offset:1792 sc1
    buffer_load_dwordx4 a[252:255], v4, s[16:19], s101 offen offset:2688 sc1
    s_waitcnt vmcnt(0)
    v_mfma_f32_32x32x16_bf16 v[96:111], a[144:147], a[240:243], v[96:111]
    v_mfma_f32_32x32x16_bf16 v[112:127], a[148:151], a[240:243], v[112:127]
    v_mfma_f32_32x32x16_bf16 v[96:111], a[152:155], a[244:247], v[96:111]
    v_mfma_f32_32x32x16_bf16 v[112:127], a[156:159], a[244:247], v[112:127]
    v_mfma_f32_32x32x16_bf16 v[96:111], a[160:163], a[248:251], v[96:111]
    v_mfma_f32_32x32x16_bf16 v[112:127], a[164:167], a[248:251], v[112:127]
    v_mfma_f32_32x32x16_bf16 v[96:111], a[168:171], a[252:255], v[96:111]
    v_mfma_f32_32x32x16_bf16 v[112:127], a[172:175], a[252:255], v[112:127]
    s_nop 15
    s_add_u32 s101, s70, s6
    buffer_load_dwordx4 a[240:243], v4, s[16:19], s101 offen offset:0 sc1
    buffer_load_dwordx4 a[244:247], v4, s[16:19], s101 offen offset:896 sc1
    buffer_load_dwordx4 a[248:251], v4, s[16:19], s101 offen offset:1792 sc1
    buffer_load_dwordx4 a[252:255], v4, s[16:19], s101 offen offset:2688 sc1
    s_waitcnt vmcnt(0)
    v_mfma_f32_32x32x16_bf16 v[96:111], a[176:179], a[240:243], v[96:111]
    v_mfma_f32_32x32x16_bf16 v[112:127], a[180:183], a[240:243], v[112:127]
    v_mfma_f32_32x32x16_bf16 v[96:111], a[184:187], a[244:247], v[96:111]
    v_mfma_f32_32x32x16_bf16 v[112:127], a[188:191], a[244:247], v[112:127]
    v_mfma_f32_32x32x16_bf16 v[96:111], a[192:195], a[248:251], v[96:111]
    v_mfma_f32_32x32x16_bf16 v[112:127], a[196:199], a[248:251], v[112:127]
    v_mfma_f32_32x32x16_bf16 v[96:111], a[200:203], a[252:255], v[96:111]
    v_mfma_f32_32x32x16_bf16 v[112:127], a[204:207], a[252:255], v[112:127]
    s_nop 15
    s_add_u32 s101, s45, s6
    buffer_load_dwordx4 a[240:243], v4, s[16:19], s101 offen offset:0 sc1
    buffer_load_dwordx4 a[244:247], v4, s[16:19], s101 offen offset:896 sc1
    buffer_load_dwordx4 a[248:251], v4, s[16:19], s101 offen offset:1792 sc1
    buffer_load_dwordx4 a[252:255], v4, s[16:19], s101 offen offset:2688 sc1
    s_waitcnt vmcnt(0)
    v_mfma_f32_32x32x16_bf16 v[96:111], a[208:211], a[240:243], v[96:111]
    v_mfma_f32_32x32x16_bf16 v[112:127], a[212:215], a[240:243], v[112:127]
    v_mfma_f32_32x32x16_bf16 v[96:111], a[216:219], a[244:247], v[96:111]
    v_mfma_f32_32x32x16_bf16 v[112:127], a[220:223], a[244:247], v[112:127]
    v_mfma_f32_32x32x16_bf16 v[96:111], a[224:227], a[248:251], v[96:111]
    v_mfma_f32_32x32x16_bf16 v[112:127], a[228:231], a[248:251], v[112:127]
    v_mfma_f32_32x32x16_bf16 v[96:111], a[232:235], a[252:255], v[96:111]
    v_mfma_f32_32x32x16_bf16 v[112:127], a[236:239], a[252:255], v[112:127]
    s_nop 10
    v_cmp_u_f32 vcc, v96, v96
    s_nop 15
    s_cbranch_vccnz redo_48
    s_branch back_49
xre_50:
    s_add_u32 s78, s78, 1
    s_cmp_ge_u32 s78, 0x8000
    s_cbranch_scc1 xback_51
    buffer_load_dwordx4 v[216:219], v3, s[16:19], s11 offen offset:0 sc1
    buffer_load_dwordx2 v[220:221], v8, s[16:19], s11 offen offset:1024 sc1
    s_waitcnt vmcnt(0)
    v_xor_b32 v219, s52, v219
    v_xor_b32 v221, s52, v221
    v_or_b32 v221, v219, v221
    v_mov_b32 v219, v220
    v_cmp_ne_u32 vcc, 0, v221
    s_nop 0
    s_cbranch_vccnz xre_50
    s_branch xback_51
redo_52:
    s_waitcnt vmcnt(0)
    s_add_u32 s78, s78, 64
    s_cmp_ge_u32 s78, 0x8000
    s_cbranch_scc1 back_53
    s_add_u32 s101, s68, s7
    buffer_load_dwordx4 a[240:243], v4, s[16:19], s101 offen offset:0 sc1
    buffer_load_dwordx4 a[244:247], v4, s[16:19], s101 offen offset:896 sc1
    buffer_load_dwordx4 a[248:251], v4, s[16:19], s101 offen offset:1792 sc1
    buffer_load_dwordx4 a[252:255], v4, s[16:19], s101 offen offset:2688 sc1
    s_waitcnt vmcnt(0)
    v_mfma_f32_32x32x16_bf16 v[128:143], a[112:115], a[240:243], 0
    v_mfma_f32_32x32x16_bf16 v[144:159], a[116:119], a[240:243], 0
    v_mfma_f32_32x32x16_bf16 v[128:143], a[120:123], a[244:247], v[128:143]
    v_mfma_f32_32x32x16_bf16 v[144:159], a[124:127], a[244:247], v[144:159]
    v_mfma_f32_32x32x16_bf16 v[128:143], a[128:131], a[248:251], v[128:143]
    v_mfma_f32_32x32x16_bf16 v[144:159], a[132:135], a[248:251], v[144:159]
    v_mfma_f32_32x32x16_bf16 v[128:143], a[136:139], a[252:255], v[128:143]
    v_mfma_f32_32x32x16_bf16 v[144:159], a[140:143], a[252:255], v[144:159]
    s_nop 15
    s_add_u32 s101, s69, s7
    buffer_load_dwordx4 a[240:243], v4, s[16:19], s101 offen offset:0 sc1
    buffer_load_dwordx4 a[244:247], v4, s[16:19], s101 offen offset:896 sc1
    buffer_load_dwordx4 a[248:251], v4, s[16:19], s101 offen offset:1792 sc1
    buffer_load_dwordx4 a[252:255], v4, s[16:19], s101 offen offset:2688 sc1
    s_waitcnt vmcnt(0)
    v_mfma_f32_32x32x16_bf16 v[128:143], a[144:147], a[240:243], v[128:143]
    v_mfma_f32_32x32x16_bf16 v[144:159], a[148:151], a[240:243], v[144:159]
    v_mfma_f32_32x32x16_bf16 v[128:143], a[152:155], a[244:247], v[128:143]
    v_mfma_f32_32x32x16_bf16 v[144:159], a[156:159], a[244:247], v[144:159]
    v_mfma_f32_32x32x16_bf16 v[128:143], a[160:163], a[248:251], v[128:143]
    v_mfma_f32_32x32x16_bf16 v[144:159], a[164:167], a[248:251], v[144:159]
    v_mfma_f32_32x32x16_bf16 v[128:143], a[168:171], a[252:255], v[128:143]
    v_mfma_f32_32x32x16_bf16 v[144:159], a[172:175], a[252:255], v[144:159]
    s_nop 15
    s_add_u32 s101, s70, s7
    buffer_load_dwordx4 a[240:243], v4, s[16:19], s101 offen offset:0 sc1
    buffer_load_dwordx4 a[244:247], v4, s[16:19], s101 offen offset:896 sc1
    buffer_load_dwordx4 a[248:251], v4, s[16:19], s101 offen offset:1792 sc1
    buffer_load_dwordx4 a[252:255], v4, s[16:19], s101 offen offset:2688 sc1
    s_waitcnt vmcnt(0)
    v_mfma_f32_32x32x16_bf16 v[128:143], a[176:179], a[240:243], v[128:143]
    v_mfma_f32_32x32x16_bf16 v[144:159], a[180:183], a[240:243], v[144:159]
    v_mfma_f32_32x32x16_bf16 v[128:143], a[184:187], a[244:247], v[128:143]
    v_mfma_f32_32x32x16_bf16 v[144:159], a[188:191], a[244:247], v[144:159]
    v_mfma_f32_32x32x16_bf16 v[128:143], a[192:195], a[248:251], v[128:143]
    v_mfma_f32_32x32x16_bf16 v[144:159], a[196:199], a[248:251], v[144:159]
    v_mfma_f32_32x32x16_bf16 v[128:143], a[200:203], a[252:255], v[128:143]
    v_mfma_f32_32x32x16_bf16 v[144:159], a[204:207], a[252:255], v[144:159]
    s_nop 15
    s_add_u32 s101, s45, s7
    buffer_load_dwordx4 a[240:243], v4, s[16:19], s101 offen offset:0 sc1
    buffer_load_dwordx4 a[244:247], v4, s[16:19], s101 offen offset:896 sc1
    buffer_load_dwordx4 a[248:251], v4, s[16:19], s101 offen offset:1792 sc1
    buffer_load_dwordx4 a[252:255], v4, s[16:19], s101 offen offset:2688 sc1
    s_waitcnt vmcnt(0)
    v_mfma_f32_32x32x16_bf16 v[128:143], a[208:211], a[240:243], v[128:143]
    v_mfma_f32_32x32x16_bf16 v[144:159], a[212:215], a[240:243], v[144:159]
    v_mfma_f32_32x32x16_bf16 v[128:143], a[216:219], a[244:247], v[128:143]
    v_mfma_f32_32x32x16_bf16 v[144:159], a[220:223], a[244:247], v[144:159]
    v_mfma_f32_32x32x16_bf16 v[128:143], a[224:227], a[248:251], v[128:143]
    v_mfma_f32_32x32x16_bf16 v[144:159], a[228:231], a[248:251], v[144:159]
    v_mfma_f32_32x32x16_bf16 v[128:143], a[232:235], a[252:255], v[128:143]
    v_mfma_f32_32x32x16_bf16 v[144:159], a[236:239], a[252:255], v[144:159]
    s_nop 10
    v_cmp_u_f32 vcc, v128, v128
    s_nop 15
    s_cbranch_vccnz redo_52
    s_branch back_53
xre_54:
    s_add_u32 s78, s78, 1
    s_cmp_ge_u32 s78, 0x8000
    s_cbranch_scc1 xback_55
    buffer_load_dwordx4 v[224:227], v3, s[16:19], s11 offen offset:2048 sc1
    buffer_load_dwordx2 v[228:229], v8, s[16:19], s11 offen offset:3072 sc1
    s_waitcnt vmcnt(0)
    v_xor_b32 v227, s52, v227
    v_xor_b32 v229, s52, v229
    v_or_b32 v229, v227, v229
    v_mov_b32 v227, v228
    v_cmp_ne_u32 vcc, 0, v229
    s_nop 0
    s_cbranch_vccnz xre_54
    s_branch xback_55
L_spec:
poll_57:
    buffer_load_dword v27, v16, s[16:19], s22 offen sc1
    s_waitcnt vmcnt(0)
    v_cmp_eq_u32 vcc, -1, v27
    s_nop 0
    s_cbranch_vccz pdone_58
    s_add_u32 s78, s78, 1
    s_cmp_lt_u32 s78, 0x8000
    s_cbranch_scc1 poll_57
pdone_58:
    s_branch join_38
f_56e0:
    s_add_u32 s78, s78, 1
    s_cmp_ge_u32 s78, 0x8000
    s_cbranch_scc1 f_56b0
    s_waitcnt vmcnt(0)
    s_add_u32 s101, s46, s8
    buffer_load_dwordx4 v[32:35], v4, s[16:19], s101 offen offset:0 sc1
f_56n0_0:
    v_cmp_eq_u32 vcc, -1, v36
    s_nop 0
    s_cbranch_vccz f_56n0_1
    buffer_load_dwordx4 v[36:39], v4, s[16:19], s101 offen offset:896 sc1
f_56n0_1:
    s_add_u32 s101, s47, s8
    v_cmp_eq_u32 vcc, -1, v40
    s_nop 0
    s_cbranch_vccz f_56n0_2
    buffer_load_dwordx4 v[40:43], v4, s[16:19], s101 offen offset:0 sc1
f_56n0_2:
    v_cmp_eq_u32 vcc, -1, v44
    s_nop 0
    s_cbranch_vccz f_56n0_3
    buffer_load_dwordx4 v[44:47], v4, s[16:19], s101 offen offset:896 sc1
f_56n0_3:
    s_waitcnt vmcnt(0)
    v_cmp_eq_u32 vcc, -1, v32
    s_nop 0
    s_cbranch_vccnz f_56e0
    s_branch f_56b0
f_56e1:
    s_add_u32 s78, s78, 1
    s_cmp_ge_u32 s78, 0x8000
    s_cbranch_scc1 f_56b1
    s_add_u32 s101, s46, s8
    s_waitcnt vmcnt(0)
    buffer_load_dwordx4 v[36:39], v4, s[16:19], s101 offen offset:896 sc1
f_56n1_1:
    s_add_u32 s101, s47, s8
    v_cmp_eq_u32 vcc, -1, v40
    s_nop 0
    s_cbranch_vccz f_56n1_2
    buffer_load_dwordx4 v[40:43], v4, s[16:19], s101 offen offset:0 sc1
f_56n1_2:
    v_cmp_eq_u32 vcc, -1, v44
    s_nop 0
    s_cbranch_vccz f_56n1_3
    buffer_load_dwordx4 v[44:47], v4, s[16:19], s101 offen offset:896 sc1
f_56n1_3:
    s_add_u32 s101, s91, s8
    v_cmp_eq_u32 vcc, -1, v48
    s_nop 0
    s_cbranch_vccz f_56n1_4
    buffer_load_dwordx4 v[48:51], v4, s[16:19], s101 offen offset:0 sc1
f_56n1_4:
    s_waitcnt vmcnt(0)
    v_cmp_eq_u32 vcc, -1, v36
    s_nop 0
    s_cbranch_vccnz f_56e1
    s_branch f_56b1
f_56e2:
    s_add_u32 s78, s78, 1
    s_cmp_ge_u32 s78, 0x8000
    s_cbranch_scc1 f_56b2
    s_waitcnt vmcnt(0)
    s_add_u32 s101, s47, s8
    buffer_load_dwordx4 v[40:43], v4, s[16:19], s101 offen offset:0 sc1
f_56n2_2:
    v_cmp_eq_u32 vcc, -1, v44
    s_nop 0
    s_cbranch_vccz f_56n2_3
    buffer_load_dwordx4 v[44:47], v4, s[16:19], s101 offen offset:896 sc1
f_56n2_3:
    s_add_u32 s101, s91, s8
    v_cmp_eq_u32 vcc, -1, v48
    s_nop 0
    s_cbranch_vccz f_56n2_4
    buffer_load_dwordx4 v[48:51], v4, s[16:19], s101 offen offset:0 sc1
f_56n2_4:
    v_cmp_eq_u32 vcc, -1, v52
    s_nop 0
    s_cbranch_vccz f_56n2_5
    buffer_load_dwordx4 v[52:55], v4, s[16:19], s101 offen offset:896 sc1
f_56n2_5:
    s_waitcnt vmcnt(0)
    v_cmp_eq_u32 vcc, -1, v40
    s_nop 0
    s_cbranch_vccnz f_56e2
    s_branch f_56b2
f_56e3:
    s_add_u32 s78, s78, 1
    s_cmp_ge_u32 s78, 0x8000
    s_cbranch_scc1 f_56b3
    s_add_u32 s101, s47, s8
    s_waitcnt vmcnt(0)
    buffer_load_dwordx4 v[44:47], v4, s[16:19], s101 offen offset:896 sc1
f_56n3_3:
    s_add_u32 s101, s91, s8
    v_cmp_eq_u32 vcc, -1, v48
    s_nop 0
    s_cbranch_vccz f_56n3_4
    buffer_load_dwordx4 v[48:51], v4, s[16:19], s101 offen offset:0 sc1
f_56n3_4:
    v_cmp_eq_u32 vcc, -1, v52
    s_nop 0
    s_cbranch_vccz f_56n3_5
    buffer_load_dwordx4 v[52:55], v4, s[16:19], s101 offen offset:896 sc1
f_56n3_5:
    s_add_u32 s101, s92, s8
    v_cmp_eq_u32 vcc, -1, v56
    s_nop 0
    s_cbranch_vccz f_56n3_6
    buffer_load_dwordx4 v[56:59], v4, s[16:19], s101 offen offset:0 sc1
f_56n3_6:
    s_waitcnt vmcnt(0)
    v_cmp_eq_u32 vcc, -1, v44
    s_nop 0
    s_cbranch_vccnz f_56e3
    s_branch f_56b3
f_56e4:
    s_add_u32 s78, s78, 1
    s_cmp_ge_u32 s78, 0x8000
    s_cbranch_scc1 f_56b4
    s_waitcnt vmcnt(0)
    s_add_u32 s101, s91, s8
    buffer_load_dwordx4 v[48:51], v4, s[16:19], s101 offen offset:0 sc1
f_56n4_4:
    v_cmp_eq_u32 vcc, -1, v52
    s_nop 0
    s_cbranch_vccz f_56n4_5
    buffer_load_dwordx4 v[52:55], v4, s[16:19], s101 offen offset:896 sc1
f_56n4_5:
    s_add_u32 s101, s92, s8
    v_cmp_eq_u32 vcc, -1, v56
    s_nop 0
    s_cbranch_vccz f_56n4_6
    buffer_load_dwordx4 v[56:59], v4, s[16:19], s101 offen offset:0 sc1
f_56n4_6:
    v_cmp_eq_u32 vcc, -1, v60
    s_nop 0
    s_cbranch_vccz f_56n4_7
    buffer_load_dwordx4 v[60:63], v4, s[16:19], s101 offen offset:896 sc1
f_56n4_7:
    s_waitcnt vmcnt(0)
    v_cmp_eq_u32 vcc, -1, v48
    s_nop 0
    s_cbranch_vccnz f_56e4
    s_branch f_56b4
f_56e5:
    s_add_u32 s78, s78, 1
    s_cmp_ge_u32 s78, 0x8000
    s_cbranch_scc1 f_56b5
    s_add_u32 s101, s91, s8
    s_waitcnt vmcnt(0)
    buffer_load_dwordx4 v[52:55], v4, s[16:19], s101 offen offset:896 sc1
f_56n5_5:
    s_add_u32 s101, s92, s8
    v_cmp_eq_u32 vcc, -1, v56
    s_nop 0
    s_cbranch_vccz f_56n5_6
    buffer_load_dwordx4 v[56:59], v4, s[16:19], s101 offen offset:0 sc1
f_56n5_6:
    v_cmp_eq_u32 vcc, -1, v60
    s_nop 0
    s_cbranch_vccz f_56n5_7
    buffer_load_dwordx4 v[60:63], v4, s[16:19], s101 offen offset:896 sc1
f_56n5_7:
    s_add_u32 s101, s51, s8
    v_cmp_eq_u32 vcc, -1, v64
    s_nop 0
    s_cbranch_vccz f_56n5_8
    buffer_load_dwordx4 v[64:67], v4, s[16:19], s101 offen offset:0 sc1
f_56n5_8:
    s_waitcnt vmcnt(0)
    v_cmp_eq_u32 vcc, -1, v52
    s_nop 0
    s_cbranch_vccnz f_56e5
    s_branch f_56b5
f_56e6:
    s_add_u32 s78, s78, 1
    s_cmp_ge_u32 s78, 0x8000
    s_cbranch_scc1 f_56b6
    s_waitcnt vmcnt(0)
    s_add_u32 s101, s92, s8
    buffer_load_dwordx4 v[56:59], v4, s[16:19], s101 offen offset:0 sc1
f_56n6_6:
    v_cmp_eq_u32 vcc, -1, v60
    s_nop 0
    s_cbranch_vccz f_56n6_7
    buffer_load_dwordx4 v[60:63], v4, s[16:19], s101 offen offset:896 sc1
f_56n6_7:
    s_add_u32 s101, s51, s8
    v_cmp_eq_u32 vcc, -1, v64
    s_nop 0
    s_cbranch_vccz f_56n6_8
    buffer_load_dwordx4 v[64:67], v4, s[16:19], s101 offen offset:0 sc1
f_56n6_8:
    v_cmp_eq_u32 vcc, -1, v68
    s_nop 0
    s_cbranch_vccz f_56n6_9
    buffer_load_dwordx4 v[68:71], v4, s[16:19], s101 offen offset:896 sc1
f_56n6_9:
    s_waitcnt vmcnt(0)
    v_cmp_eq_u32 vcc, -1, v56
    s_nop 0
    s_cbranch_vccnz f_56e6
    s_branch f_56b6
re_59:
    s_add_u32 s78, s78, 1
    s_cmp_ge_u32 s78, 0x8000
    s_cbranch_scc1 bk_60
    buffer_load_dword v31, v20, s[16:19], s87 offen sc1
    s_waitcnt vmcnt(0)
    v_cmp_ne_u32 vcc, s52, v31
    s_nop 0
    s_cbranch_vccnz re_59
    s_branch bk_60
f_56e7:
    s_add_u32 s78, s78, 1
    s_cmp_ge_u32 s78, 0x8000
    s_cbranch_scc1 f_56b7
    s_add_u32 s101, s92, s8
    s_waitcnt vmcnt(0)
    buffer_load_dwordx4 v[60:63], v4, s[16:19], s101 offen offset:896 sc1
f_56n7_7:
    s_add_u32 s101, s51, s8
    v_cmp_eq_u32 vcc, -1, v64
    s_nop 0
    s_cbranch_vccz f_56n7_8
    buffer_load_dwordx4 v[64:67], v4, s[16:19], s101 offen offset:0 sc1
f_56n7_8:
    v_cmp_eq_u32 vcc, -1, v68
    s_nop 0
    s_cbranch_vccz f_56n7_9
    buffer_load_dwordx4 v[68:71], v4, s[16:19], s101 offen offset:896 sc1
f_56n7_9:
    s_add_u32 s101, s62, s8
    v_cmp_eq_u32 vcc, -1, v72
    s_nop 0
    s_cbranch_vccz f_56n7_10
    buffer_load_dwordx4 v[72:75], v4, s[16:19], s101 offen offset:0 sc1
f_56n7_10:
    s_waitcnt vmcnt(0)
    v_cmp_eq_u32 vcc, -1, v60
    s_nop 0
    s_cbranch_vccnz f_56e7
    s_branch f_56b7
f_56e8:
    s_add_u32 s78, s78, 1
    s_cmp_ge_u32 s78, 0x8000
    s_cbranch_scc1 f_56b8
    s_waitcnt vmcnt(0)
    s_add_u32 s101, s51, s8
    buffer_load_dwordx4 v[64:67], v4, s[16:19], s101 offen offset:0 sc1
f_56n8_8:
    v_cmp_eq_u32 vcc, -1, v68
    s_nop 0
    s_cbranch_vccz f_56n8_9
    buffer_load_dwordx4 v[68:71], v4, s[16:19], s101 offen offset:896 sc1
f_56n8_9:
    s_add_u32 s101, s62, s8
    v_cmp_eq_u32 vcc, -1, v72
    s_nop 0
    s_cbranch_vccz f_56n8_10
    buffer_load_dwordx4 v[72:75], v4, s[16:19], s101 offen offset:0 sc1
f_56n8_10:
    v_cmp_eq_u32 vcc, -1, v76
    s_nop 0
    s_cbranch_vccz f_56n8_11
    buffer_load_dwordx4 v[76:79], v4, s[16:19], s101 offen offset:896 sc1
f_56n8_11:
    s_waitcnt vmcnt(0)
    v_cmp_eq_u32 vcc, -1, v64
    s_nop 0
    s_cbranch_vccnz f_56e8
    s_branch f_56b8
f_56e9:
    s_add_u32 s78, s78, 1
    s_cmp_ge_u32 s78, 0x8000
    s_cbranch_scc1 f_56b9
    s_add_u32 s101, s51, s8
    s_waitcnt vmcnt(0)
    buffer_load_dwordx4 v[68:71], v4, s[16:19], s101 offen offset:896 sc1
f_56n9_9:
    s_add_u32 s101, s62, s8
    v_cmp_eq_u32 vcc, -1, v72
    s_nop 0
    s_cbranch_vccz f_56n9_10
    buffer_load_dwordx4 v[72:75], v4, s[16:19], s101 offen offset:0 sc1
f_56n9_10:
    v_cmp_eq_u32 vcc, -1, v76
    s_nop 0
    s_cbranch_vccz f_56n9_11
    buffer_load_dwordx4 v[76:79], v4, s[16:19], s101 offen offset:896 sc1
f_56n9_11:
    s_add_u32 s101, s100, s8
    v_cmp_eq_u32 vcc, -1, v80
    s_nop 0
    s_cbranch_vccz f_56n9_12
    buffer_load_dwordx4 v[80:83], v4, s[16:19], s101 offen offset:0 sc1
f_56n9_12:
    s_waitcnt vmcnt(0)
    v_cmp_eq_u32 vcc, -1, v68
    s_nop 0
    s_cbranch_vccnz f_56e9
    s_branch f_56b9
f_56e10:
    s_add_u32 s78, s78, 1
    s_cmp_ge_u32 s78, 0x8000
    s_cbranch_scc1 f_56b10
    s_waitcnt vmcnt(0)
    s_add_u32 s101, s62, s8
    buffer_load_dwordx4 v[72:75], v4, s[16:19], s101 offen offset:0 sc1
f_56n10_10:
    v_cmp_eq_u32 vcc, -1, v76
    s_nop 0
    s_cbranch_vccz f_56n10_11
    buffer_load_dwordx4 v[76:79], v4, s[16:19], s101 offen offset:896 sc1
f_56n10_11:
    s_add_u32 s101, s100, s8
    v_cmp_eq_u32 vcc, -1, v80
    s_nop 0
    s_cbranch_vccz f_56n10_12
    buffer_load_dwordx4 v[80:83], v4, s[16:19], s101 offen offset:0 sc1
f_56n10_12:
    v_cmp_eq_u32 vcc, -1, v84
    s_nop 0
    s_cbranch_vccz f_56n10_13
    buffer_load_dwordx4 v[84:87], v4, s[16:19], s101 offen offset:896 sc1
f_56n10_13:
    s_waitcnt vmcnt(0)
    v_cmp_eq_u32 vcc, -1, v72
    s_nop 0
    s_cbranch_vccnz f_56e10
    s_branch f_56b10
f_56e11:
    s_add_u32 s78, s78, 1
    s_cmp_ge_u32 s78, 0x8000
    s_cbranch_scc1 f_56b11
    s_add_u32 s101, s62, s8
    s_waitcnt vmcnt(0)
    buffer_load_dwordx4 v[76:79], v4, s[16:19], s101 offen offset:896 sc1
f_56n11_11:
    s_add_u32 s101, s100, s8
    v_cmp_eq_u32 vcc, -1, v80
    s_nop 0
    s_cbranch_vccz f_56n11_12
    buffer_load_dwordx4 v[80:83], v4, s[16:19], s101 offen offset:0 sc1
f_56n11_12:
    v_cmp_eq_u32 vcc, -1, v84
    s_nop 0
    s_cbranch_vccz f_56n11_13
    buffer_load_dwordx4 v[84:87], v4, s[16:19], s101 offen offset:896 sc1
f_56n11_13:
    s_waitcnt vmcnt(0)
    v_cmp_eq_u32 vcc, -1, v76
    s_nop 0
    s_cbranch_vccnz f_56e11
    s_branch f_56b11
f_56e12:
    s_add_u32 s78, s78, 1
    s_cmp_ge_u32 s78, 0x8000
    s_cbranch_scc1 f_56b12
    s_waitcnt vmcnt(0)
    s_add_u32 s101, s100, s8
    buffer_load_dwordx4 v[80:83], v4, s[16:19], s101 offen offset:0 sc1
f_56n12_12:
    v_cmp_eq_u32 vcc, -1, v84
    s_nop 0
    s_cbranch_vccz f_56n12_13
    buffer_load_dwordx4 v[84:87], v4, s[16:19], s101 offen offset:896 sc1
f_56n12_13:
    s_waitcnt vmcnt(0)
    v_cmp_eq_u32 vcc, -1, v80
    s_nop 0
    s_cbranch_vccnz f_56e12
    s_branch f_56b12
re_61:
    s_add_u32 s78, s78, 1
    s_cmp_ge_u32 s78, 0x8000
    s_cbranch_scc1 bk_62
    buffer_load_dword v27, v16, s[16:19], s22 offen sc1
    s_waitcnt vmcnt(0)
    v_cmp_eq_u32 vcc, -1, v27
    s_nop 0
    s_cbranch_vccnz re_61
    s_branch bk_62
f_56e13:
    s_add_u32 s78, s78, 1
    s_cmp_ge_u32 s78, 0x8000
    s_cbranch_scc1 f_56b13
    s_add_u32 s101, s100, s8
    s_waitcnt vmcnt(0)
    buffer_load_dwordx4 v[84:87], v4, s[16:19], s101 offen offset:896 sc1
f_56n13_13:
    s_waitcnt vmcnt(0)
    v_cmp_eq_u32 vcc, -1, v84
    s_nop 0
    s_cbranch_vccnz f_56e13
    s_branch f_56b13
f_56e14:
    s_add_u32 s78, s78, 1
    s_cmp_ge_u32 s78, 0x8000
    s_cbranch_scc1 f_56b14
    s_waitcnt vmcnt(0)
    s_add_u32 s101, s46, s9
    buffer_load_dwordx4 v[88:91], v4, s[16:19], s101 offen offset:0 sc1
f_56n14_14:
    v_cmp_eq_u32 vcc, -1, v92
    s_nop 0
    s_cbranch_vccz f_56n14_15
    buffer_load_dwordx4 v[92:95], v4, s[16:19], s101 offen offset:896 sc1
f_56n14_15:
    s_add_u32 s101, s47, s9
    v_cmp_eq_u32 vcc, -1, v32
    s_nop 0
    s_cbranch_vccz f_56n14_16
    buffer_load_dwordx4 v[32:35], v4, s[16:19], s101 offen offset:0 sc1
f_56n14_16:
    v_cmp_eq_u32 vcc, -1, v36
    s_nop 0
    s_cbranch_vccz f_56n14_17
    buffer_load_dwordx4 v[36:39], v4, s[16:19], s101 offen offset:896 sc1
f_56n14_17:
    s_waitcnt vmcnt(0)
    v_cmp_eq_u32 vcc, -1, v88
    s_nop 0
    s_cbranch_vccnz f_56e14
    s_branch f_56b14
f_56e15:
    s_add_u32 s78, s78, 1
    s_cmp_ge_u32 s78, 0x8000
    s_cbranch_scc1 f_56b15
    s_add_u32 s101, s46, s9
    s_waitcnt vmcnt(0)
    buffer_load_dwordx4 v[92:95], v4, s[16:19], s101 offen offset:896 sc1
f_56n15_15:
    s_add_u32 s101, s47, s9
    v_cmp_eq_u32 vcc, -1, v32
    s_nop 0
    s_cbranch_vccz f_56n15_16
    buffer_load_dwordx4 v[32:35], v4, s[16:19], s101 offen offset:0 sc1
f_56n15_16:
    v_cmp_eq_u32 vcc, -1, v36
    s_nop 0
    s_cbranch_vccz f_56n15_17
    buffer_load_dwordx4 v[36:39], v4, s[16:19], s101 offen offset:896 sc1
f_56n15_17:
    s_add_u32 s101, s91, s9
    v_cmp_eq_u32 vcc, -1, v40
    s_nop 0
    s_cbranch_vccz f_56n15_18
    buffer_load_dwordx4 v[40:43], v4, s[16:19], s101 offen offset:0 sc1
f_56n15_18:
    s_waitcnt vmcnt(0)
    v_cmp_eq_u32 vcc, -1, v92
    s_nop 0
    s_cbranch_vccnz f_56e15
    s_branch f_56b15
f_56e16:
    s_add_u32 s78, s78, 1
    s_cmp_ge_u32 s78, 0x8000
    s_cbranch_scc1 f_56b16
    s_waitcnt vmcnt(0)
    s_add_u32 s101, s47, s9
    buffer_load_dwordx4 v[32:35], v4, s[16:19], s101 offen offset:0 sc1
f_56n16_16:
    v_cmp_eq_u32 vcc, -1, v36
    s_nop 0
    s_cbranch_vccz f_56n16_17
    buffer_load_dwordx4 v[36:39], v4, s[16:19], s101 offen offset:896 sc1
f_56n16_17:
    s_add_u32 s101, s91, s9
    v_cmp_eq_u32 vcc, -1, v40
    s_nop 0
    s_cbranch_vccz f_56n16_18
    buffer_load_dwordx4 v[40:43], v4, s[16:19], s101 offen offset:0 sc1
f_56n16_18:
    v_cmp_eq_u32 vcc, -1, v44
    s_nop 0
    s_cbranch_vccz f_56n16_19
    buffer_load_dwordx4 v[44:47], v4, s[16:19], s101 offen offset:896 sc1
f_56n16_19:
    s_waitcnt vmcnt(0)
    v_cmp_eq_u32 vcc, -1, v32
    s_nop 0
    s_cbranch_vccnz f_56e16
    s_branch f_56b16
f_56e17:
    s_add_u32 s78, s78, 1
    s_cmp_ge_u32 s78, 0x8000
    s_cbranch_scc1 f_56b17
    s_add_u32 s101, s47, s9
    s_waitcnt vmcnt(0)
    buffer_load_dwordx4 v[36:39], v4, s[16:19], s101 offen offset:896 sc1
f_56n17_17:
    s_add_u32 s101, s91, s9
    v_cmp_eq_u32 vcc, -1, v40
    s_nop 0
    s_cbranch_vccz f_56n17_18
    buffer_load_dwordx4 v[40:43], v4, s[16:19], s101 offen offset:0 sc1
f_56n17_18:
    v_cmp_eq_u32 vcc, -1, v44
    s_nop 0
    s_cbranch_vccz f_56n17_19
    buffer_load_dwordx4 v[44:47], v4, s[16:19], s101 offen offset:896 sc1
f_56n17_19:
    s_add_u32 s101, s92, s9
    v_cmp_eq_u32 vcc, -1, v48
    s_nop 0
    s_cbranch_vccz f_56n17_20
    buffer_load_dwordx4 v[48:51], v4, s[16:19], s101 offen offset:0 sc1
f_56n17_20:
    s_waitcnt vmcnt(0)
    v_cmp_eq_u32 vcc, -1, v36
    s_nop 0
    s_cbranch_vccnz f_56e17
    s_branch f_56b17
f_56e18:
    s_add_u32 s78, s78, 1
    s_cmp_ge_u32 s78, 0x8000
    s_cbranch_scc1 f_56b18
    s_waitcnt vmcnt(0)
    s_add_u32 s101, s91, s9
    buffer_load_dwordx4 v[40:43], v4, s[16:19], s101 offen offset:0 sc1
f_56n18_18:
    v_cmp_eq_u32 vcc, -1, v44
    s_nop 0
    s_cbranch_vccz f_56n18_19
    buffer_load_dwordx4 v[44:47], v4, s[16:19], s101 offen offset:896 sc1
f_56n18_19:
    s_add_u32 s101, s92, s9
    v_cmp_eq_u32 vcc, -1, v48
    s_nop 0
    s_cbranch_vccz f_56n18_20
    buffer_load_dwordx4 v[48:51], v4, s[16:19], s101 offen offset:0 sc1
f_56n18_20:
    v_cmp_eq_u32 vcc, -1, v52
    s_nop 0
    s_cbranch_vccz f_56n18_21
    buffer_load_dwordx4 v[52:55], v4, s[16:19], s101 offen offset:896 sc1
f_56n18_21:
    s_waitcnt vmcnt(0)
    v_cmp_eq_u32 vcc, -1, v40
    s_nop 0
    s_cbranch_vccnz f_56e18
    s_branch f_56b18
f_56e19:
    s_add_u32 s78, s78, 1
    s_cmp_ge_u32 s78, 0x8000
    s_cbranch_scc1 f_56b19
    s_add_u32 s101, s91, s9
    s_waitcnt vmcnt(0)
    buffer_load_dwordx4 v[44:47], v4, s[16:19], s101 offen offset:896 sc1
f_56n19_19:
    s_add_u32 s101, s92, s9
    v_cmp_eq_u32 vcc, -1, v48
    s_nop 0
    s_cbranch_vccz f_56n19_20
    buffer_load_dwordx4 v[48:51], v4, s[16:19], s101 offen offset:0 sc1
f_56n19_20:
    v_cmp_eq_u32 vcc, -1, v52
    s_nop 0
    s_cbranch_vccz f_56n19_21
    buffer_load_dwordx4 v[52:55], v4, s[16:19], s101 offen offset:896 sc1
f_56n19_21:
    s_add_u32 s101, s51, s9
    v_cmp_eq_u32 vcc, -1, v56
    s_nop 0
    s_cbranch_vccz f_56n19_22
    buffer_load_dwordx4 v[56:59], v4, s[16:19], s101 offen offset:0 sc1
f_56n19_22:
    s_waitcnt vmcnt(0)
    v_cmp_eq_u32 vcc, -1, v44
    s_nop 0
    s_cbranch_vccnz f_56e19
    s_branch f_56b19
f_56e20:
    s_add_u32 s78, s78, 1
    s_cmp_ge_u32 s78, 0x8000
    s_cbranch_scc1 f_56b20
    s_waitcnt vmcnt(0)
    s_add_u32 s101, s92, s9
    buffer_load_dwordx4 v[48:51], v4, s[16:19], s101 offen offset:0 sc1
f_56n20_20:
    v_cmp_eq_u32 vcc, -1, v52
    s_nop 0
    s_cbranch_vccz f_56n20_21
    buffer_load_dwordx4 v[52:55], v4, s[16:19], s101 offen offset:896 sc1
f_56n20_21:
    s_add_u32 s101, s51, s9
    v_cmp_eq_u32 vcc, -1, v56
    s_nop 0
    s_cbranch_vccz f_56n20_22
    buffer_load_dwordx4 v[56:59], v4, s[16:19], s101 offen offset:0 sc1
f_56n20_22:
    v_cmp_eq_u32 vcc, -1, v60
    s_nop 0
    s_cbranch_vccz f_56n20_23
    buffer_load_dwordx4 v[60:63], v4, s[16:19], s101 offen offset:896 sc1
f_56n20_23:
    s_waitcnt vmcnt(0)
    v_cmp_eq_u32 vcc, -1, v48
    s_nop 0
    s_cbranch_vccnz f_56e20
    s_branch f_56b20
f_56e21:
    s_add_u32 s78, s78, 1
    s_cmp_ge_u32 s78, 0x8000
    s_cbranch_scc1 f_56b21
    s_add_u32 s101, s92, s9
    s_waitcnt vmcnt(0)
    buffer_load_dwordx4 v[52:55], v4, s[16:19], s101 offen offset:896 sc1
f_56n21_21:
    s_add_u32 s101, s51, s9
    v_cmp_eq_u32 vcc, -1, v56
    s_nop 0
    s_cbranch_vccz f_56n21_22
    buffer_load_dwordx4 v[56:59], v4, s[16:19], s101 offen offset:0 sc1
f_56n21_22:
    v_cmp_eq_u32 vcc, -1, v60
    s_nop 0
    s_cbranch_vccz f_56n21_23
    buffer_load_dwordx4 v[60:63], v4, s[16:19], s101 offen offset:896 sc1
f_56n21_23:
    s_add_u32 s101, s62, s9
    v_cmp_eq_u32 vcc, -1, v64
    s_nop 0
    s_cbranch_vccz f_56n21_24
    buffer_load_dwordx4 v[64:67], v4, s[16:19], s101 offen offset:0 sc1
f_56n21_24:
    s_waitcnt vmcnt(0)
    v_cmp_eq_u32 vcc, -1, v52
    s_nop 0
    s_cbranch_vccnz f_56e21
    s_branch f_56b21
f_56e22:
    s_add_u32 s78, s78, 1
    s_cmp_ge_u32 s78, 0x8000
    s_cbranch_scc1 f_56b22
    s_waitcnt vmcnt(0)
    s_add_u32 s101, s51, s9
    buffer_load_dwordx4 v[56:59], v4, s[16:19], s101 offen offset:0 sc1
f_56n22_22:
    v_cmp_eq_u32 vcc, -1, v60
    s_nop 0
    s_cbranch_vccz f_56n22_23
    buffer_load_dwordx4 v[60:63], v4, s[16:19], s101 offen offset:896 sc1
f_56n22_23:
    s_add_u32 s101, s62, s9
    v_cmp_eq_u32 vcc, -1, v64
    s_nop 0
    s_cbranch_vccz f_56n22_24
    buffer_load_dwordx4 v[64:67], v4, s[16:19], s101 offen offset:0 sc1
f_56n22_24:
    v_cmp_eq_u32 vcc, -1, v68
    s_nop 0
    s_cbranch_vccz f_56n22_25
    buffer_load_dwordx4 v[68:71], v4, s[16:19], s101 offen offset:896 sc1
f_56n22_25:
    s_waitcnt vmcnt(0)
    v_cmp_eq_u32 vcc, -1, v56
    s_nop 0
    s_cbranch_vccnz f_56e22
    s_branch f_56b22
f_56e23:
    s_add_u32 s78, s78, 1
    s_cmp_ge_u32 s78, 0x8000
    s_cbranch_scc1 f_56b23
    s_add_u32 s101, s51, s9
    s_waitcnt vmcnt(0)
    buffer_load_dwordx4 v[60:63], v4, s[16:19], s101 offen offset:896 sc1
f_56n23_23:
    s_add_u32 s101, s62, s9
    v_cmp_eq_u32 vcc, -1, v64
    s_nop 0
    s_cbranch_vccz f_56n23_24
    buffer_load_dwordx4 v[64:67], v4, s[16:19], s101 offen offset:0 sc1
f_56n23_24:
    v_cmp_eq_u32 vcc, -1, v68
    s_nop 0
    s_cbranch_vccz f_56n23_25
    buffer_load_dwordx4 v[68:71], v4, s[16:19], s101 offen offset:896 sc1
f_56n23_25:
    s_add_u32 s101, s100, s9
    v_cmp_eq_u32 vcc, -1, v72
    s_nop 0
    s_cbranch_vccz f_56n23_26
    buffer_load_dwordx4 v[72:75], v4, s[16:19], s101 offen offset:0 sc1
f_56n23_26:
    s_waitcnt vmcnt(0)
    v_cmp_eq_u32 vcc, -1, v60
    s_nop 0
    s_cbranch_vccnz f_56e23
    s_branch f_56b23
f_56e24:
    s_add_u32 s78, s78, 1
    s_cmp_ge_u32 s78, 0x8000
    s_cbranch_scc1 f_56b24
    s_waitcnt vmcnt(0)
    s_add_u32 s101, s62, s9
    buffer_load_dwordx4 v[64:67], v4, s[16:19], s101 offen offset:0 sc1
f_56n24_24:
    v_cmp_eq_u32 vcc, -1, v68
    s_nop 0
    s_cbranch_vccz f_56n24_25
    buffer_load_dwordx4 v[68:71], v4, s[16:19], s101 offen offset:896 sc1
f_56n24_25:
    s_add_u32 s101, s100, s9
    v_cmp_eq_u32 vcc, -1, v72
    s_nop 0
    s_cbranch_vccz f_56n24_26
    buffer_load_dwordx4 v[72:75], v4, s[16:19], s101 offen offset:0 sc1
f_56n24_26:
    v_cmp_eq_u32 vcc, -1, v76
    s_nop 0
    s_cbranch_vccz f_56n24_27
    buffer_load_dwordx4 v[76:79], v4, s[16:19], s101 offen offset:896 sc1
f_56n24_27:
    s_waitcnt vmcnt(0)
    v_cmp_eq_u32 vcc, -1, v64
    s_nop 0
    s_cbranch_vccnz f_56e24
    s_branch f_56b24
f_56e25:
    s_add_u32 s78, s78, 1
    s_cmp_ge_u32 s78, 0x8000
    s_cbranch_scc1 f_56b25
    s_add_u32 s101, s62, s9
    s_waitcnt vmcnt(0)
    buffer_load_dwordx4 v[68:71], v4, s[16:19], s101 offen offset:896 sc1
f_56n25_25:
    s_add_u32 s101, s100, s9
    v_cmp_eq_u32 vcc, -1, v72
    s_nop 0
    s_cbranch_vccz f_56n25_26
    buffer_load_dwordx4 v[72:75], v4, s[16:19], s101 offen offset:0 sc1
f_56n25_26:
    v_cmp_eq_u32 vcc, -1, v76
    s_nop 0
    s_cbranch_vccz f_56n25_27
    buffer_load_dwordx4 v[76:79], v4, s[16:19], s101 offen offset:896 sc1
f_56n25_27:
    s_waitcnt vmcnt(0)
    v_cmp_eq_u32 vcc, -1, v68
    s_nop 0
    s_cbranch_vccnz f_56e25
    s_branch f_56b25
f_56e26:
    s_add_u32 s78, s78, 1
    s_cmp_ge_u32 s78, 0x8000
    s_cbranch_scc1 f_56b26
    s_waitcnt vmcnt(0)
    s_add_u32 s101, s100, s9
    buffer_load_dwordx4 v[72:75], v4, s[16:19], s101 offen offset:0 sc1
f_56n26_26:
    v_cmp_eq_u32 vcc, -1, v76
    s_nop 0
    s_cbranch_vccz f_56n26_27
    buffer_load_dwordx4 v[76:79], v4, s[16:19], s101 offen offset:896 sc1
f_56n26_27:
    s_waitcnt vmcnt(0)
    v_cmp_eq_u32 vcc, -1, v72
    s_nop 0
    s_cbranch_vccnz f_56e26
    s_branch f_56b26
re_63:
    s_add_u32 s78, s78, 1
    s_cmp_ge_u32 s78, 0x8000
    s_cbranch_scc1 bk_64
    buffer_load_dword v25, v16, s[16:19], s95 offen sc1
    s_waitcnt vmcnt(0)
    v_cmp_eq_u32 vcc, -1, v25
    s_nop 0
    s_cbranch_vccnz re_63
    s_branch bk_64
f_56e27:
    s_add_u32 s78, s78, 1
    s_cmp_ge_u32 s78, 0x8000
    s_cbranch_scc1 f_56b27
    s_add_u32 s101, s100, s9
    s_waitcnt vmcnt(0)
    buffer_load_dwordx4 v[76:79], v4, s[16:19], s101 offen offset:896 sc1
f_56n27_27:
    s_waitcnt vmcnt(0)
    v_cmp_eq_u32 vcc, -1, v76
    s_nop 0
    s_cbranch_vccnz f_56e27
    s_branch f_56b27
redo_65:
    s_waitcnt vmcnt(0)
    s_add_u32 s78, s78, 64
    s_cmp_ge_u32 s78, 0x8000
    s_cbranch_scc1 back_66
    s_add_u32 s101, s46, s8
    buffer_load_dwordx4 a[240:243], v4, s[16:19], s101 offen offset:0 sc1
    buffer_load_dwordx4 a[244:247], v4, s[16:19], s101 offen offset:896 sc1
    s_add_u32 s101, s47, s8
    buffer_load_dwordx4 a[248:251], v4, s[16:19], s101 offen offset:0 sc1
    buffer_load_dwordx4 a[252:255], v4, s[16:19], s101 offen offset:896 sc1
    s_waitcnt vmcnt(0)
    v_mfma_f32_32x32x16_bf16 v[96:111], a[0:3], a[240:243], 0
    v_mfma_f32_32x32x16_bf16 v[112:127], a[4:7], a[240:243], 0
    v_mfma_f32_32x32x16_bf16 v[96:111], a[8:11], a[244:247], v[96:111]
    v_mfma_f32_32x32x16_bf16 v[112:127], a[12:15], a[244:247], v[112:127]
    v_mfma_f32_32x32x16_bf16 v[96:111], a[16:19], a[248:251], v[96:111]
    v_mfma_f32_32x32x16_bf16 v[112:127], a[20:23], a[248:251], v[112:127]
    v_mfma_f32_32x32x16_bf16 v[96:111], a[24:27], a[252:255], v[96:111]
    v_mfma_f32_32x32x16_bf16 v[112:127], a[28:31], a[252:255], v[112:127]
    s_nop 15
    s_add_u32 s101, s91, s8
    buffer_load_dwordx4 a[240:243], v4, s[16:19], s101 offen offset:0 sc1
    buffer_load_dwordx4 a[244:247], v4, s[16:19], s101 offen offset:896 sc1
    s_add_u32 s101, s92, s8
    buffer_load_dwordx4 a[248:251], v4, s[16:19], s101 offen offset:0 sc1
    buffer_load_dwordx4 a[252:255], v4, s[16:19], s101 offen offset:896 sc1
    s_waitcnt vmcnt(0)
    v_mfma_f32_32x32x16_bf16 v[96:111], a[32:35], a[240:243], v[96:111]
    v_mfma_f32_32x32x16_bf16 v[112:127], a[36:39], a[240:243], v[112:127]
    v_mfma_f32_32x32x16_bf16 v[96:111], a[40:43], a[244:247], v[96:111]
    v_mfma_f32_32x32x16_bf16 v[112:127], a[44:47], a[244:247], v[112:127]
    v_mfma_f32_32x32x16_bf16 v[96:111], a[48:51], a[248:251], v[96:111]
    v_mfma_f32_32x32x16_bf16 v[112:127], a[52:55], a[248:251], v[112:127]
    v_mfma_f32_32x32x16_bf16 v[96:111], a[56:59], a[252:255], v[96:111]
    v_mfma_f32_32x32x16_bf16 v[112:127], a[60:63], a[252:255], v[112:127]
    s_nop 15
    s_add_u32 s101, s51, s8
    buffer_load_dwordx4 a[240:243], v4, s[16:19], s101 offen offset:0 sc1
    buffer_load_dwordx4 a[244:247], v4, s[16:19], s101 offen offset:896 sc1
    s_add_u32 s101, s62, s8
    buffer_load_dwordx4 a[248:251], v4, s[16:19], s101 offen offset:0 sc1
    buffer_load_dwordx4 a[252:255], v4, s[16:19], s101 offen offset:896 sc1
    s_waitcnt vmcnt(0)
    v_mfma_f32_32x32x16_bf16 v[96:111], a[64:67], a[240:243], v[96:111]
    v_mfma_f32_32x32x16_bf16 v[112:127], a[68:71], a[240:243], v[112:127]
    v_mfma_f32_32x32x16_bf16 v[96:111], a[72:75], a[244:247], v[96:111]
    v_mfma_f32_32x32x16_bf16 v[112:127], a[76:79], a[244:247], v[112:127]
    v_mfma_f32_32x32x16_bf16 v[96:111], a[80:83], a[248:251], v[96:111]
    v_mfma_f32_32x32x16_bf16 v[112:127], a[84:87], a[248:251], v[112:127]
    v_mfma_f32_32x32x16_bf16 v[96:111], a[88:91], a[252:255], v[96:111]
    v_mfma_f32_32x32x16_bf16 v[112:127], a[92:95], a[252:255], v[112:127]
    s_nop 15
    s_add_u32 s101, s100, s8
    buffer_load_dwordx4 a[240:243], v4, s[16:19], s101 offen offset:0 sc1
    buffer_load_dwordx4 a[244:247], v4, s[16:19], s101 offen offset:896 sc1
    s_waitcnt vmcnt(0)
    v_mfma_f32_32x32x16_bf16 v[96:111], a[96:99], a[240:243], v[96:111]
    v_mfma_f32_32x32x16_bf16 v[112:127], a[100:103], a[240:243], v[112:127]
    v_mfma_f32_32x32x16_bf16 v[96:111], a[104:107], a[244:247], v[96:111]
    v_mfma_f32_32x32x16_bf16 v[112:127], a[108:111], a[244:247], v[112:127]
    s_nop 10
    v_cmp_u_f32 vcc, v96, v96
    s_nop 15
    s_cbranch_vccnz redo_65
    s_branch back_66
redo_67:
    s_waitcnt vmcnt(0)
    s_add_u32 s78, s78, 64
    s_cmp_ge_u32 s78, 0x8000
    s_cbranch_scc1 back_68
    s_add_u32 s101, s46, s9
    buffer_load_dwordx4 a[240:243], v4, s[16:19], s101 offen offset:0 sc1
    buffer_load_dwordx4 a[244:247], v4, s[16:19], s101 offen offset:896 sc1
    s_add_u32 s101, s47, s9
    buffer_load_dwordx4 a[248:251], v4, s[16:19], s101 offen offset:0 sc1
    buffer_load_dwordx4 a[252:255], v4, s[16:19], s101 offen offset:896 sc1
    s_waitcnt vmcnt(0)
    v_mfma_f32_32x32x16_bf16 v[128:143], a[0:3], a[240:243], 0
    v_mfma_f32_32x32x16_bf16 v[144:159], a[4:7], a[240:243], 0
    v_mfma_f32_32x32x16_bf16 v[128:143], a[8:11], a[244:247], v[128:143]
    v_mfma_f32_32x32x16_bf16 v[144:159], a[12:15], a[244:247], v[144:159]
    v_mfma_f32_32x32x16_bf16 v[128:143], a[16:19], a[248:251], v[128:143]
    v_mfma_f32_32x32x16_bf16 v[144:159], a[20:23], a[248:251], v[144:159]
    v_mfma_f32_32x32x16_bf16 v[128:143], a[24:27], a[252:255], v[128:143]
    v_mfma_f32_32x32x16_bf16 v[144:159], a[28:31], a[252:255], v[144:159]
    s_nop 15
    s_add_u32 s101, s91, s9
    buffer_load_dwordx4 a[240:243], v4, s[16:19], s101 offen offset:0 sc1
    buffer_load_dwordx4 a[244:247], v4, s[16:19], s101 offen offset:896 sc1
    s_add_u32 s101, s92, s9
    buffer_load_dwordx4 a[248:251], v4, s[16:19], s101 offen offset:0 sc1
    buffer_load_dwordx4 a[252:255], v4, s[16:19], s101 offen offset:896 sc1
    s_waitcnt vmcnt(0)
    v_mfma_f32_32x32x16_bf16 v[128:143], a[32:35], a[240:243], v[128:143]
    v_mfma_f32_32x32x16_bf16 v[144:159], a[36:39], a[240:243], v[144:159]
    v_mfma_f32_32x32x16_bf16 v[128:143], a[40:43], a[244:247], v[128:143]
    v_mfma_f32_32x32x16_bf16 v[144:159], a[44:47], a[244:247], v[144:159]
    v_mfma_f32_32x32x16_bf16 v[128:143], a[48:51], a[248:251], v[128:143]
    v_mfma_f32_32x32x16_bf16 v[144:159], a[52:55], a[248:251], v[144:159]
    v_mfma_f32_32x32x16_bf16 v[128:143], a[56:59], a[252:255], v[128:143]
    v_mfma_f32_32x32x16_bf16 v[144:159], a[60:63], a[252:255], v[144:159]
    s_nop 15
    s_add_u32 s101, s51, s9
    buffer_load_dwordx4 a[240:243], v4, s[16:19], s101 offen offset:0 sc1
    buffer_load_dwordx4 a[244:247], v4, s[16:19], s101 offen offset:896 sc1
    s_add_u32 s101, s62, s9
    buffer_load_dwordx4 a[248:251], v4, s[16:19], s101 offen offset:0 sc1
    buffer_load_dwordx4 a[252:255], v4, s[16:19], s101 offen offset:896 sc1
    s_waitcnt vmcnt(0)
    v_mfma_f32_32x32x16_bf16 v[128:143], a[64:67], a[240:243], v[128:143]
    v_mfma_f32_32x32x16_bf16 v[144:159], a[68:71], a[240:243], v[144:159]
    v_mfma_f32_32x32x16_bf16 v[128:143], a[72:75], a[244:247], v[128:143]
    v_mfma_f32_32x32x16_bf16 v[144:159], a[76:79], a[244:247], v[144:159]
    v_mfma_f32_32x32x16_bf16 v[128:143], a[80:83], a[248:251], v[128:143]
    v_mfma_f32_32x32x16_bf16 v[144:159], a[84:87], a[248:251], v[144:159]
    v_mfma_f32_32x32x16_bf16 v[128:143], a[88:91], a[252:255], v[128:143]
    v_mfma_f32_32x32x16_bf16 v[144:159], a[92:95], a[252:255], v[144:159]
    s_nop 15
    s_add_u32 s101, s100, s9
    buffer_load_dwordx4 a[240:243], v4, s[16:19], s101 offen offset:0 sc1
    buffer_load_dwordx4 a[244:247], v4, s[16:19], s101 offen offset:896 sc1
    s_waitcnt vmcnt(0)
    v_mfma_f32_32x32x16_bf16 v[128:143], a[96:99], a[240:243], v[128:143]
    v_mfma_f32_32x32x16_bf16 v[144:159], a[100:103], a[240:243], v[144:159]
    v_mfma_f32_32x32x16_bf16 v[128:143], a[104:107], a[244:247], v[128:143]
    v_mfma_f32_32x32x16_bf16 v[144:159], a[108:111], a[244:247], v[144:159]
    s_nop 10
    v_cmp_u_f32 vcc, v128, v128
    s_nop 15
    s_cbranch_vccnz redo_67
    s_branch back_68
redo_69:
    s_waitcnt vmcnt(0)
    s_add_u32 s78, s78, 64
    s_cmp_ge_u32 s78, 0x8000
    s_cbranch_scc1 back_70
    s_add_u32 s101, s46, s20
    buffer_load_dwordx4 a[240:243], v4, s[16:19], s101 offen offset:0 sc1
    buffer_load_dwordx4 a[244:247], v4, s[16:19], s101 offen offset:896 sc1
    s_add_u32 s101, s47, s20
    buffer_load_dwordx4 a[248:251], v4, s[16:19], s101 offen offset:0 sc1
    buffer_load_dwordx4 a[252:255], v4, s[16:19], s101 offen offset:896 sc1
    s_waitcnt vmcnt(0)
    v_mfma_f32_32x32x16_bf16 v[96:111], a[0:3], a[240:243], 0
    v_mfma_f32_32x32x16_bf16 v[112:127], a[4:7], a[240:243], 0
    v_mfma_f32_32x32x16_bf16 v[96:111], a[8:11], a[244:247], v[96:111]
    v_mfma_f32_32x32x16_bf16 v[112:127], a[12:15], a[244:247], v[112:127]
    v_mfma_f32_32x32x16_bf16 v[96:111], a[16:19], a[248:251], v[96:111]
    v_mfma_f32_32x32x16_bf16 v[112:127], a[20:23], a[248:251], v[112:127]
    v_mfma_f32_32x32x16_bf16 v[96:111], a[24:27], a[252:255], v[96:111]
    v_mfma_f32_32x32x16_bf16 v[112:127], a[28:31], a[252:255], v[112:127]
    s_nop 15
    s_add_u32 s101, s91, s20
    buffer_load_dwordx4 a[240:243], v4, s[16:19], s101 offen offset:0 sc1
    buffer_load_dwordx4 a[244:247], v4, s[16:19], s101 offen offset:896 sc1
    s_add_u32 s101, s92, s20
    buffer_load_dwordx4 a[248:251], v4, s[16:19], s101 offen offset:0 sc1
    buffer_load_dwordx4 a[252:255], v4, s[16:19], s101 offen offset:896 sc1
    s_waitcnt vmcnt(0)
    v_mfma_f32_32x32x16_bf16 v[96:111], a[32:35], a[240:243], v[96:111]
    v_mfma_f32_32x32x16_bf16 v[112:127], a[36:39], a[240:243], v[112:127]
    v_mfma_f32_32x32x16_bf16 v[96:111], a[40:43], a[244:247], v[96:111]
    v_mfma_f32_32x32x16_bf16 v[112:127], a[44:47], a[244:247], v[112:127]
    v_mfma_f32_32x32x16_bf16 v[96:111], a[48:51], a[248:251], v[96:111]
    v_mfma_f32_32x32x16_bf16 v[112:127], a[52:55], a[248:251], v[112:127]
    v_mfma_f32_32x32x16_bf16 v[96:111], a[56:59], a[252:255], v[96:111]
    v_mfma_f32_32x32x16_bf16 v[112:127], a[60:63], a[252:255], v[112:127]
    s_nop 15
    s_add_u32 s101, s51, s20
    buffer_load_dwordx4 a[240:243], v4, s[16:19], s101 offen offset:0 sc1
    buffer_load_dwordx4 a[244:247], v4, s[16:19], s101 offen offset:896 sc1
    s_add_u32 s101, s62, s20
    buffer_load_dwordx4 a[248:251], v4, s[16:19], s101 offen offset:0 sc1
    buffer_load_dwordx4 a[252:255], v4, s[16:19], s101 offen offset:896 sc1
    s_waitcnt vmcnt(0)
    v_mfma_f32_32x32x16_bf16 v[96:111], a[64:67], a[240:243], v[96:111]
    v_mfma_f32_32x32x16_bf16 v[112:127], a[68:71], a[240:243], v[112:127]
    v_mfma_f32_32x32x16_bf16 v[96:111], a[72:75], a[244:247], v[96:111]
    v_mfma_f32_32x32x16_bf16 v[112:127], a[76:79], a[244:247], v[112:127]
    v_mfma_f32_32x32x16_bf16 v[96:111], a[80:83], a[248:251], v[96:111]
    v_mfma_f32_32x32x16_bf16 v[112:127], a[84:87], a[248:251], v[112:127]
    v_mfma_f32_32x32x16_bf16 v[96:111], a[88:91], a[252:255], v[96:111]
    v_mfma_f32_32x32x16_bf16 v[112:127], a[92:95], a[252:255], v[112:127]
    s_nop 15
    s_add_u32 s101, s100, s20
    buffer_load_dwordx4 a[240:243], v4, s[16:19], s101 offen offset:0 sc1
    buffer_load_dwordx4 a[244:247], v4, s[16:19], s101 offen offset:896 sc1
    s_waitcnt vmcnt(0)
    v_mfma_f32_32x32x16_bf16 v[96:111], a[96:99], a[240:243], v[96:111]
    v_mfma_f32_32x32x16_bf16 v[112:127], a[100:103], a[240:243], v[112:127]
    v_mfma_f32_32x32x16_bf16 v[96:111], a[104:107], a[244:247], v[96:111]
    v_mfma_f32_32x32x16_bf16 v[112:127], a[108:111], a[244:247], v[112:127]
    s_nop 10
    v_cmp_u_f32 vcc, v96, v96
    s_nop 15
    s_cbranch_vccnz redo_69
    s_branch back_70
xre_71:
    s_add_u32 s78, s78, 1
    s_cmp_ge_u32 s78, 0x8000
    s_cbranch_scc1 xback_72
    buffer_load_dwordx4 v[216:219], v3, s[16:19], s94 offen offset:0 sc1
    buffer_load_dwordx2 v[220:221], v8, s[16:19], s94 offen offset:1024 sc1
    s_waitcnt vmcnt(0)
    v_xor_b32 v219, s52, v219
    v_xor_b32 v221, s52, v221
    v_or_b32 v221, v219, v221
    v_mov_b32 v219, v220
    v_cmp_ne_u32 vcc, 0, v221
    s_nop 0
    s_cbranch_vccnz xre_71
    s_branch xback_72
redo_73:
    s_waitcnt vmcnt(0)
    s_add_u32 s78, s78, 64
    s_cmp_ge_u32 s78, 0x8000
    s_cbranch_scc1 back_74
    s_add_u32 s101, s46, s21
    buffer_load_dwordx4 a[240:243], v4, s[16:19], s101 offen offset:0 sc1
    buffer_load_dwordx4 a[244:247], v4, s[16:19], s101 offen offset:896 sc1
    s_add_u32 s101, s47, s21
    buffer_load_dwordx4 a[248:251], v4, s[16:19], s101 offen offset:0 sc1
    buffer_load_dwordx4 a[252:255], v4, s[16:19], s101 offen offset:896 sc1
    s_waitcnt vmcnt(0)
    v_mfma_f32_32x32x16_bf16 v[128:143], a[0:3], a[240:243], 0
    v_mfma_f32_32x32x16_bf16 v[144:159], a[4:7], a[240:243], 0
    v_mfma_f32_32x32x16_bf16 v[128:143], a[8:11], a[244:247], v[128:143]
    v_mfma_f32_32x32x16_bf16 v[144:159], a[12:15], a[244:247], v[144:159]
    v_mfma_f32_32x32x16_bf16 v[128:143], a[16:19], a[248:251], v[128:143]
    v_mfma_f32_32x32x16_bf16 v[144:159], a[20:23], a[248:251], v[144:159]
    v_mfma_f32_32x32x16_bf16 v[128:143], a[24:27], a[252:255], v[128:143]
    v_mfma_f32_32x32x16_bf16 v[144:159], a[28:31], a[252:255], v[144:159]
    s_nop 15
    s_add_u32 s101, s91, s21
    buffer_load_dwordx4 a[240:243], v4, s[16:19], s101 offen offset:0 sc1
    buffer_load_dwordx4 a[244:247], v4, s[16:19], s101 offen offset:896 sc1
    s_add_u32 s101, s92, s21
    buffer_load_dwordx4 a[248:251], v4, s[16:19], s101 offen offset:0 sc1
    buffer_load_dwordx4 a[252:255], v4, s[16:19], s101 offen offset:896 sc1
    s_waitcnt vmcnt(0)
    v_mfma_f32_32x32x16_bf16 v[128:143], a[32:35], a[240:243], v[128:143]
    v_mfma_f32_32x32x16_bf16 v[144:159], a[36:39], a[240:243], v[144:159]
    v_mfma_f32_32x32x16_bf16 v[128:143], a[40:43], a[244:247], v[128:143]
    v_mfma_f32_32x32x16_bf16 v[144:159], a[44:47], a[244:247], v[144:159]
    v_mfma_f32_32x32x16_bf16 v[128:143], a[48:51], a[248:251], v[128:143]
    v_mfma_f32_32x32x16_bf16 v[144:159], a[52:55], a[248:251], v[144:159]
    v_mfma_f32_32x32x16_bf16 v[128:143], a[56:59], a[252:255], v[128:143]
    v_mfma_f32_32x32x16_bf16 v[144:159], a[60:63], a[252:255], v[144:159]
    s_nop 15
    s_add_u32 s101, s51, s21
    buffer_load_dwordx4 a[240:243], v4, s[16:19], s101 offen offset:0 sc1
    buffer_load_dwordx4 a[244:247], v4, s[16:19], s101 offen offset:896 sc1
    s_add_u32 s101, s62, s21
    buffer_load_dwordx4 a[248:251], v4, s[16:19], s101 offen offset:0 sc1
    buffer_load_dwordx4 a[252:255], v4, s[16:19], s101 offen offset:896 sc1
    s_waitcnt vmcnt(0)
    v_mfma_f32_32x32x16_bf16 v[128:143], a[64:67], a[240:243], v[128:143]
    v_mfma_f32_32x32x16_bf16 v[144:159], a[68:71], a[240:243], v[144:159]
    v_mfma_f32_32x32x16_bf16 v[128:143], a[72:75], a[244:247], v[128:143]
    v_mfma_f32_32x32x16_bf16 v[144:159], a[76:79], a[244:247], v[144:159]
    v_mfma_f32_32x32x16_bf16 v[128:143], a[80:83], a[248:251], v[128:143]
    v_mfma_f32_32x32x16_bf16 v[144:159], a[84:87], a[248:251], v[144:159]
    v_mfma_f32_32x32x16_bf16 v[128:143], a[88:91], a[252:255], v[128:143]
    v_mfma_f32_32x32x16_bf16 v[144:159], a[92:95], a[252:255], v[144:159]
    s_nop 15
    s_add_u32 s101, s100, s21
    buffer_load_dwordx4 a[240:243], v4, s[16:19], s101 offen offset:0 sc1
    buffer_load_dwordx4 a[244:247], v4, s[16:19], s101 offen offset:896 sc1
    s_waitcnt vmcnt(0)
    v_mfma_f32_32x32x16_bf16 v[128:143], a[96:99], a[240:243], v[128:143]
    v_mfma_f32_32x32x16_bf16 v[144:159], a[100:103], a[240:243], v[144:159]
    v_mfma_f32_32x32x16_bf16 v[128:143], a[104:107], a[244:247], v[128:143]
    v_mfma_f32_32x32x16_bf16 v[144:159], a[108:111], a[244:247], v[144:159]
    s_nop 10
    v_cmp_u_f32 vcc, v128, v128
    s_nop 15
    s_cbranch_vccnz redo_73
    s_branch back_74
xre_75:
    s_add_u32 s78, s78, 1
    s_cmp_ge_u32 s78, 0x8000
    s_cbranch_scc1 xback_76
    buffer_load_dwordx4 v[224:227], v3, s[16:19], s94 offen offset:2048 sc1
    buffer_load_dwordx2 v[228:229], v8, s[16:19], s94 offen offset:3072 sc1
    s_waitcnt vmcnt(0)
    v_xor_b32 v227, s52, v227
    v_xor_b32 v229, s52, v229
    v_or_b32 v229, v227, v229
    v_mov_b32 v227, v228
    v_cmp_ne_u32 vcc, 0, v229
    s_nop 0
    s_cbranch_vccnz xre_75
    s_branch xback_76
L_fin:
    s_endpgm
.section .rodata,"a"
.p2align 6
.amdhsa_kernel sequential_preLN__linear_kernel_hedgehog__mixer_token_mlp__prompt_kernel
  .amdhsa_next_free_vgpr 512
  .amdhsa_next_free_sgpr 102
  .amdhsa_accum_offset 256
  .amdhsa_group_segment_fixed_size 0
  .amdhsa_kernarg_size 96
  .amdhsa_user_sgpr_count 2
  .amdhsa_user_sgpr_kernarg_segment_ptr 1
  .amdhsa_system_sgpr_workgroup_id_x 1
.end_amdhsa_kernel
```
